```python
import torch

def _softmax(x, axis=-1):
    return torch.softmax(x, dim=axis)
def _gelu(x):
    return torch.nn.functional.gelu(x, approximate="tanh")
def _silu(x):
    return torch.nn.functional.silu(x)
def _sigmoid(x):
    return torch.sigmoid(x)
def _layernorm(x, axis=-1, eps=1e-5):
    m = x.mean(dim=axis, keepdim=True)
    v = x.var(dim=axis, keepdim=True, unbiased=False)
    return (x - m) / torch.sqrt(v + eps)
def _scatter_add(tgt, idx, src, axis=0):
    return tgt.clone().index_add_(axis, idx, src)
def _segment_sum(src, seg, n):
    out = torch.zeros((n,) + src.shape[1:], dtype=src.dtype)
    return out.index_add_(0, seg, src)
def _pad(x, pw):
    flat = tuple(v for pair in reversed(pw) for v in pair)
    return torch.nn.functional.pad(x, flat)

kernel_name = 'gated_mix__ssm_conv_s4__dense_activation_silu__prompt'

def setup_inputs():

    _w = (lambda a: (lambda t: t.to(torch.bfloat16) if t.is_floating_point() else t)(torch.as_tensor(a)))
    def _A_setup():
        B, L, D, N = 1, 2048, 512, 128
        A_re = -(lambda _x: torch.exp(torch.as_tensor(_x)))((lambda *s: torch.randn(*s, dtype=torch.bfloat16) * 6.4)(D, N))
        A_im = torch.pi * (lambda *s: torch.randn(*s, dtype=torch.bfloat16) * 0.05)(D, N)
        B_re = (lambda *s: torch.randn(*s, dtype=torch.bfloat16) * 0.2)(D, N)
        B_im = (lambda *s: torch.randn(*s, dtype=torch.bfloat16) * 0.2)(D, N)
        C_re = (lambda *s: torch.randn(*s, dtype=torch.bfloat16) * 0.2)(D, N)
        C_im = (lambda *s: torch.randn(*s, dtype=torch.bfloat16) * 0.2)(D, N)
        log_dt = (lambda *s: torch.randn(*s, dtype=torch.bfloat16) * 0.05)(D) * 0.5 - 4.0
        Dskip = (lambda *s: torch.randn(*s, dtype=torch.bfloat16) * 0.05)(D)
        return {
            "u": _w((lambda *s: torch.randn(*s, dtype=torch.bfloat16) * 0.05)(B, L, D)),
            "A_re": _w(A_re),
            "A_im": _w(A_im),
            "B_re": _w(B_re),
            "B_im": _w(B_im),
            "C_re": _w(C_re),
            "C_im": _w(C_im),
            "log_dt": _w(log_dt),
            "Dskip": _w(Dskip),
        }
    _A_in = _A_setup()

    def _B_setup():
        B, S, D, F = 1, 2048, 512, 1792
        return {
            "x": _w((lambda *s: torch.randn(*s, dtype=torch.bfloat16) * 0.05)(B, S, D)),
            "w1": _w((lambda *s: torch.randn(*s, dtype=torch.bfloat16) * 6.4)(D, F) * (D ** -0.5)),
            "w2": _w((lambda *s: torch.randn(*s, dtype=torch.bfloat16) * 0.2)(F, D) * (F ** -0.5)),
        }
    _B_in = _B_setup()

    return {
        "A_u": _A_in["u"],
        "A_A_re": _A_in["A_re"],
        "A_A_im": _A_in["A_im"],
        "A_B_re": _A_in["B_re"],
        "A_B_im": _A_in["B_im"],
        "A_C_re": _A_in["C_re"],
        "A_C_im": _A_in["C_im"],
        "A_log_dt": _A_in["log_dt"],
        "A_Dskip": _A_in["Dskip"],
        "B_x": _B_in["x"],
        "B_w1": _B_in["w1"],
        "B_w2": _B_in["w2"],
        "gate_w": _w((lambda *s: torch.randn(*s, dtype=torch.bfloat16) * 0.05)(512) * 16.0),
    }

def reference(A_u, A_A_re, A_A_im, A_B_re, A_B_im, A_C_re, A_C_im, A_log_dt, A_Dskip, B_x, B_w1, B_w2, gate_w):
    def _A_ref(u, A_re, A_im, B_re, B_im, C_re, C_im, log_dt, Dskip):
        Bsz, L, D = u.shape
        dt = torch.exp(log_dt)[:, None]
        A = A_re + 1j * A_im
        Bc = B_re + 1j * B_im
        Cc = C_re + 1j * C_im
        logdA = dt * A
        dB = dt * Bc
        l = (lambda x, dt: x.to(dt))(torch.arange(L), A_re.dtype)
        P = torch.exp(logdA[:, :, None] * l[None, None, :])
        K = torch.einsum("dn,dnl,dn->dl", Cc, P, dB).real
        L2 = 2 * L
        Kp = _pad(K, ((0, 0), (0, L)))
        up = (lambda x, *d: x.permute(*d))(u, 0, 2, 1)
        up = _pad(up, ((0, 0), (0, 0), (0, L)))
        Kf = (lambda x, axes=(-2,-1): torch.fft.rfft2(x.float(), dim=axes))(Kp[:, None, :], axes=(-2, -1))
        Uf = (lambda x, axes=(-2,-1): torch.fft.rfft2(x.float(), dim=axes))(up[:, :, None, :], axes=(-2, -1))
        Yf = Uf * Kf[None, :, :, :]
        y = (lambda x, s, axes=(-2,-1): torch.fft.irfft2(x, s=s, dim=axes).to(torch.bfloat16))(Yf, (1, L2), axes=(-2, -1))[:, :, 0, :L]
        y = (lambda x, *d: x.permute(*d))(y, 0, 2, 1) + u * Dskip[None, None, :]
        return y

    def _B_ref(x, w1, w2):
        h = torch.einsum("bsd,df->bsf", x, w1)
        h = _silu(h)
        out = torch.einsum("bsf,fd->bsd", h, w2)
        return out

    x = A_u
    g = _sigmoid((x * gate_w).sum(-1, keepdims=True))
    a = _A_ref(x, A_A_re, A_A_im, A_B_re, A_B_im, A_C_re, A_C_im, A_log_dt, A_Dskip)
    b = _B_ref(x, B_w1, B_w2)
    return g * a + (1 - g) * b
```

```asm
; @launch grid=(512,1,1) block=(256,1,1) lds=81920
.amdgcn_target "amdgcn-amd-amdhsa--gfx950"
.text
.globl gated_mix__ssm_conv_s4__dense_activation_silu__prompt_kernel
.p2align 8
.type gated_mix__ssm_conv_s4__dense_activation_silu__prompt_kernel,@function
gated_mix__ssm_conv_s4__dense_activation_silu__prompt_kernel:
    s_cmp_ge_u32 s2, 512
    s_cbranch_scc1 L_exit
    s_cmp_lt_u32 s2, 256
    s_cbranch_scc1 L_prep
    s_cmp_ge_u32 s2, 480
    s_cbranch_scc1 L_idle
L_gemm1:
    s_load_dwordx2 s[4:5], s[0:1], 0
    s_load_dwordx2 s[6:7], s[0:1], 80
    s_load_dwordx2 s[8:9], s[0:1], 120
    v_lshrrev_b32 v2, 6, v0
    v_and_b32 v1, 63, v0
    v_readfirstlane_b32 s20, v2
    s_and_b32 s21, s2, 7
    s_sub_u32 s22, s2, 256
    s_lshr_b32 s22, s22, 3
    s_mul_i32 s25, s22, 37
    s_lshr_b32 s25, s25, 8
    s_mul_i32 s26, s25, 7
    s_sub_u32 s26, s22, s26
    s_lshr_b32 s23, s21, 1
    s_lshl_b32 s23, s23, 2
    s_add_u32 s23, s23, s25
    s_and_b32 s24, s21, 1
    s_mul_i32 s24, s24, 7
    s_add_u32 s24, s24, s26
    v_lshrrev_b32 v3, 3, v1
    v_and_b32 v4, 7, v1
    v_lshrrev_b32 v5, 4, v1
    v_xor_b32 v4, v4, v5
    v_lshlrev_b32 v3, 10, v3
    v_lshl_add_u32 v200, v4, 4, v3
    v_xor_b32 v201, 64, v200
    v_add_u32 v201, 7168, v201
    v_add_u32 v202, 14336, v200
    v_add_u32 v203, 14336, v201
    v_lshrrev_b32 v3, 4, v1
    v_and_b32 v4, 15, v1
    v_lshlrev_b32 v5, 1, v3
    v_xor_b32 v4, v4, v5
    s_and_b32 s27, s20, 1
    s_lshl_b32 s27, s27, 3
    v_xor_b32 v4, s27, v4
    v_mul_u32_u24 v3, 3584, v3
    v_lshl_add_u32 v11, v4, 4, v3
    v_add_u32 v9, 13312, v11
    s_lshl_b32 s32, s23, 17
    s_lshl_b32 s33, s20, 15
    s_add_u32 s32, s32, s33
    s_lshl_b32 s34, s24, 8
    s_mul_i32 s35, s20, 28672
    s_add_u32 s34, s34, s35
    s_lshl_b32 s36, s20, 12
    s_lshl_b32 s35, s20, 11
    s_lshl_b32 s44, s22, 2
    s_add_u32 s44, s44, s20
    s_lshl_b32 s44, s44, 6
    v_add_u32 v3, s44, v1
    v_lshlrev_b32 v204, 7, v3
    v_mul_u32_u24 v4, 74899, v3
    v_lshrrev_b32 v4, 20, v4
    v_mul_u32_u24 v5, 14, v4
    v_sub_u32 v5, v3, v5
    v_mul_u32_u24 v4, 3584, v4
    v_lshl_add_u32 v205, v5, 7, v4
    s_and_b32 s45, s21, 1
    s_mul_i32 s45, s45, 1792
    s_lshr_b32 s46, s21, 1
    s_lshl_b32 s46, s46, 19
    s_waitcnt lgkmcnt(0)
    s_mov_b32 s12, s4
    s_mov_b32 s13, s5
    s_mov_b32 s14, 0x200000
    s_mov_b32 s15, 0x20000
    s_mov_b32 s16, s6
    s_mov_b32 s17, s7
    s_mov_b32 s18, 0x1c0000
    s_mov_b32 s19, 0x20000
    s_add_u32 m0, s36, 0
    s_nop 0
    buffer_load_dwordx4 v200, s[12:15], s32 offen offset:0 lds
    buffer_load_dwordx4 v201, s[12:15], s32 offen offset:1024 lds
    buffer_load_dwordx4 v202, s[12:15], s32 offen offset:2048 lds
    buffer_load_dwordx4 v203, s[12:15], s32 offen offset:3072 lds
    s_add_u32 s32, s32, 128
    s_add_u32 m0, s35, 49152
    s_nop 0
    buffer_load_dwordx4 v11, s[16:19], s34 offen lds
    buffer_load_dwordx4 v9, s[16:19], s34 offen offset:1024 lds
    s_add_u32 s34, s34, 114688
    s_add_u32 m0, s35, 57344
    s_nop 0
    buffer_load_dwordx4 v11, s[16:19], s34 offen lds
    buffer_load_dwordx4 v9, s[16:19], s34 offen offset:1024 lds
    s_add_u32 s34, s34, 114688
    s_add_u32 s48, s4, s46
    s_addc_u32 s49, s5, 0
    s_mov_b32 s50, 0x80000
    s_mov_b32 s51, 0x20000
    buffer_load_dword v206, v205, s[16:19], s45 offen
    buffer_load_dword v207, v204, s[48:51], 0 offen
    s_add_u32 m0, s36, 16384
    s_nop 0
    buffer_load_dwordx4 v200, s[12:15], s32 offen offset:0 lds
    buffer_load_dwordx4 v201, s[12:15], s32 offen offset:1024 lds
    buffer_load_dwordx4 v202, s[12:15], s32 offen offset:2048 lds
    buffer_load_dwordx4 v203, s[12:15], s32 offen offset:3072 lds
    s_add_u32 s32, s32, 128
    s_add_u32 m0, s35, 65536
    s_nop 0
    buffer_load_dwordx4 v11, s[16:19], s34 offen lds
    buffer_load_dwordx4 v9, s[16:19], s34 offen offset:1024 lds
    s_add_u32 s34, s34, 114688
    s_add_u32 m0, s35, 73728
    s_nop 0
    buffer_load_dwordx4 v11, s[16:19], s34 offen lds
    buffer_load_dwordx4 v9, s[16:19], s34 offen offset:1024 lds
    s_add_u32 s34, s34, 114688
    s_add_u32 m0, s36, 32768
    s_nop 0
    buffer_load_dwordx4 v200, s[12:15], s32 offen offset:0 lds
    buffer_load_dwordx4 v201, s[12:15], s32 offen offset:1024 lds
    buffer_load_dwordx4 v202, s[12:15], s32 offen offset:2048 lds
    buffer_load_dwordx4 v203, s[12:15], s32 offen offset:3072 lds
    s_add_u32 s32, s32, 128
    s_mov_b32 s28, s8
    s_mov_b32 s29, s9
    s_mov_b32 s30, 0x700000
    s_mov_b32 s31, 0x20000
    s_lshr_b32 s37, s20, 1
    s_and_b32 s38, s20, 1
    v_and_b32 v3, 15, v1
    v_lshrrev_b32 v4, 1, v3
    v_lshrrev_b32 v5, 4, v1
    v_xor_b32 v4, v4, v5
    v_lshlrev_b32 v3, 7, v3
    v_lshl_add_u32 v12, v4, 4, v3
    s_lshl_b32 s39, s37, 13
    v_add_u32 v12, s39, v12
    v_xor_b32 v13, 64, v12
    v_bfe_u32 v4, v1, 2, 2
    v_and_b32 v3, 1, v5
    v_lshlrev_b32 v3, 2, v3
    s_lshl_b32 s39, s38, 2
    v_xor_b32 v3, s39, v3
    v_xor_b32 v3, v3, v4
    v_lshlrev_b32 v6, 11, v5
    v_lshl_add_u32 v6, v4, 8, v6
    v_and_b32 v7, 3, v1
    v_lshl_add_u32 v6, v7, 3, v6
    v_add_u32 v6, 49152, v6
    v_xor_b32 v7, 0, v3
    v_lshl_add_u32 v14, v7, 5, v6
    v_xor_b32 v7, 1, v3
    v_lshl_add_u32 v15, v7, 5, v6
    v_xor_b32 v7, 2, v3
    v_lshl_add_u32 v16, v7, 5, v6
    v_xor_b32 v7, 3, v3
    v_lshl_add_u32 v17, v7, 5, v6
    v_mov_b32 v24, 0
    v_mov_b32 v25, 0
    v_mov_b32 v26, 0
    v_mov_b32 v27, 0
    v_mov_b32 v28, 0
    v_mov_b32 v29, 0
    v_mov_b32 v30, 0
    v_mov_b32 v31, 0
    v_mov_b32 v32, 0
    v_mov_b32 v33, 0
    v_mov_b32 v34, 0
    v_mov_b32 v35, 0
    v_mov_b32 v36, 0
    v_mov_b32 v37, 0
    v_mov_b32 v38, 0
    v_mov_b32 v39, 0
    v_mov_b32 v40, 0
    v_mov_b32 v41, 0
    v_mov_b32 v42, 0
    v_mov_b32 v43, 0
    v_mov_b32 v44, 0
    v_mov_b32 v45, 0
    v_mov_b32 v46, 0
    v_mov_b32 v47, 0
    v_mov_b32 v48, 0
    v_mov_b32 v49, 0
    v_mov_b32 v50, 0
    v_mov_b32 v51, 0
    v_mov_b32 v52, 0
    v_mov_b32 v53, 0
    v_mov_b32 v54, 0
    v_mov_b32 v55, 0
    v_mov_b32 v56, 0
    v_mov_b32 v57, 0
    v_mov_b32 v58, 0
    v_mov_b32 v59, 0
    v_mov_b32 v60, 0
    v_mov_b32 v61, 0
    v_mov_b32 v62, 0
    v_mov_b32 v63, 0
    v_mov_b32 v64, 0
    v_mov_b32 v65, 0
    v_mov_b32 v66, 0
    v_mov_b32 v67, 0
    v_mov_b32 v68, 0
    v_mov_b32 v69, 0
    v_mov_b32 v70, 0
    v_mov_b32 v71, 0
    v_mov_b32 v72, 0
    v_mov_b32 v73, 0
    v_mov_b32 v74, 0
    v_mov_b32 v75, 0
    v_mov_b32 v76, 0
    v_mov_b32 v77, 0
    v_mov_b32 v78, 0
    v_mov_b32 v79, 0
    v_mov_b32 v80, 0
    v_mov_b32 v81, 0
    v_mov_b32 v82, 0
    v_mov_b32 v83, 0
    v_mov_b32 v84, 0
    v_mov_b32 v85, 0
    v_mov_b32 v86, 0
    v_mov_b32 v87, 0
    s_waitcnt vmcnt(16)
    s_barrier
    ds_read_b128 v[88:91], v12 offset:0
    ds_read_b128 v[92:95], v12 offset:2048
    ds_read_b128 v[96:99], v12 offset:4096
    ds_read_b128 v[100:103], v12 offset:6144
    ds_read_b64_tr_b16 v[104:105], v14 offset:0
    ds_read_b64_tr_b16 v[106:107], v14 offset:1024
    ds_read_b64_tr_b16 v[108:109], v15 offset:0
    ds_read_b64_tr_b16 v[110:111], v15 offset:1024
    ds_read_b64_tr_b16 v[112:113], v16 offset:0
    ds_read_b64_tr_b16 v[114:115], v16 offset:1024
    ds_read_b64_tr_b16 v[116:117], v17 offset:0
    ds_read_b64_tr_b16 v[118:119], v17 offset:1024
    s_waitcnt vmcnt(14) lgkmcnt(0)
    s_barrier
    v_mfma_f32_16x16x32_bf16 v[24:27], v[104:107], v[88:91], v[24:27]
    s_add_u32 m0, s35, 49152
    s_nop 0
    buffer_load_dwordx4 v11, s[16:19], s34 offen lds
    v_mfma_f32_16x16x32_bf16 v[40:43], v[104:107], v[92:95], v[40:43]
    buffer_load_dwordx4 v9, s[16:19], s34 offen offset:1024 lds
    s_add_u32 s34, s34, 114688
    v_mfma_f32_16x16x32_bf16 v[56:59], v[104:107], v[96:99], v[56:59]
    ds_read_b128 v[120:123], v13 offset:0
    ds_read_b128 v[124:127], v13 offset:2048
    v_mfma_f32_16x16x32_bf16 v[72:75], v[104:107], v[100:103], v[72:75]
    ds_read_b128 v[128:131], v13 offset:4096
    ds_read_b128 v[132:135], v13 offset:6144
    v_mfma_f32_16x16x32_bf16 v[28:31], v[108:111], v[88:91], v[28:31]
    ds_read_b64_tr_b16 v[136:137], v14 offset:8192
    ds_read_b64_tr_b16 v[138:139], v14 offset:9216
    v_mfma_f32_16x16x32_bf16 v[44:47], v[108:111], v[92:95], v[44:47]
    ds_read_b64_tr_b16 v[140:141], v15 offset:8192
    ds_read_b64_tr_b16 v[142:143], v15 offset:9216
    v_mfma_f32_16x16x32_bf16 v[60:63], v[108:111], v[96:99], v[60:63]
    ds_read_b64_tr_b16 v[144:145], v16 offset:8192
    ds_read_b64_tr_b16 v[146:147], v16 offset:9216
    v_mfma_f32_16x16x32_bf16 v[76:79], v[108:111], v[100:103], v[76:79]
    ds_read_b64_tr_b16 v[148:149], v17 offset:8192
    ds_read_b64_tr_b16 v[150:151], v17 offset:9216
    v_mfma_f32_16x16x32_bf16 v[32:35], v[112:115], v[88:91], v[32:35]
    v_mfma_f32_16x16x32_bf16 v[48:51], v[112:115], v[92:95], v[48:51]
    v_mfma_f32_16x16x32_bf16 v[64:67], v[112:115], v[96:99], v[64:67]
    v_mfma_f32_16x16x32_bf16 v[80:83], v[112:115], v[100:103], v[80:83]
    v_mfma_f32_16x16x32_bf16 v[36:39], v[116:119], v[88:91], v[36:39]
    v_mfma_f32_16x16x32_bf16 v[52:55], v[116:119], v[92:95], v[52:55]
    v_mfma_f32_16x16x32_bf16 v[68:71], v[116:119], v[96:99], v[68:71]
    v_mfma_f32_16x16x32_bf16 v[84:87], v[116:119], v[100:103], v[84:87]
    s_waitcnt vmcnt(8) lgkmcnt(0)
    s_barrier
    v_mfma_f32_16x16x32_bf16 v[24:27], v[136:139], v[120:123], v[24:27]
    s_add_u32 m0, s35, 57344
    s_nop 0
    buffer_load_dwordx4 v11, s[16:19], s34 offen lds
    v_mfma_f32_16x16x32_bf16 v[40:43], v[136:139], v[124:127], v[40:43]
    buffer_load_dwordx4 v9, s[16:19], s34 offen offset:1024 lds
    s_add_u32 s34, s34, 114688
    v_mfma_f32_16x16x32_bf16 v[56:59], v[136:139], v[128:131], v[56:59]
    ds_read_b128 v[88:91], v12 offset:16384
    ds_read_b128 v[92:95], v12 offset:18432
    v_mfma_f32_16x16x32_bf16 v[72:75], v[136:139], v[132:135], v[72:75]
    ds_read_b128 v[96:99], v12 offset:20480
    ds_read_b128 v[100:103], v12 offset:22528
    v_mfma_f32_16x16x32_bf16 v[28:31], v[140:143], v[120:123], v[28:31]
    ds_read_b64_tr_b16 v[104:105], v14 offset:16384
    ds_read_b64_tr_b16 v[106:107], v14 offset:17408
    v_mfma_f32_16x16x32_bf16 v[44:47], v[140:143], v[124:127], v[44:47]
    s_add_u32 m0, s36, 0
    s_nop 0
    buffer_load_dwordx4 v200, s[12:15], s32 offen offset:0 lds
    v_mfma_f32_16x16x32_bf16 v[60:63], v[140:143], v[128:131], v[60:63]
    buffer_load_dwordx4 v201, s[12:15], s32 offen offset:1024 lds
    buffer_load_dwordx4 v202, s[12:15], s32 offen offset:2048 lds
    v_mfma_f32_16x16x32_bf16 v[76:79], v[140:143], v[132:135], v[76:79]
    buffer_load_dwordx4 v203, s[12:15], s32 offen offset:3072 lds
    s_add_u32 s32, s32, 128
    v_mfma_f32_16x16x32_bf16 v[32:35], v[144:147], v[120:123], v[32:35]
    ds_read_b64_tr_b16 v[108:109], v15 offset:16384
    ds_read_b64_tr_b16 v[110:111], v15 offset:17408
    v_mfma_f32_16x16x32_bf16 v[48:51], v[144:147], v[124:127], v[48:51]
    ds_read_b64_tr_b16 v[112:113], v16 offset:16384
    ds_read_b64_tr_b16 v[114:115], v16 offset:17408
    v_mfma_f32_16x16x32_bf16 v[64:67], v[144:147], v[128:131], v[64:67]
    ds_read_b64_tr_b16 v[116:117], v17 offset:16384
    ds_read_b64_tr_b16 v[118:119], v17 offset:17408
    v_mfma_f32_16x16x32_bf16 v[80:83], v[144:147], v[132:135], v[80:83]
    v_mfma_f32_16x16x32_bf16 v[36:39], v[148:151], v[120:123], v[36:39]
    v_mfma_f32_16x16x32_bf16 v[52:55], v[148:151], v[124:127], v[52:55]
    v_mfma_f32_16x16x32_bf16 v[68:71], v[148:151], v[128:131], v[68:71]
    v_mfma_f32_16x16x32_bf16 v[84:87], v[148:151], v[132:135], v[84:87]
    s_waitcnt vmcnt(12) lgkmcnt(0)
    s_barrier
    v_mfma_f32_16x16x32_bf16 v[24:27], v[104:107], v[88:91], v[24:27]
    s_add_u32 m0, s35, 65536
    s_nop 0
    buffer_load_dwordx4 v11, s[16:19], s34 offen lds
    v_mfma_f32_16x16x32_bf16 v[40:43], v[104:107], v[92:95], v[40:43]
    buffer_load_dwordx4 v9, s[16:19], s34 offen offset:1024 lds
    s_add_u32 s34, s34, 114688
    v_mfma_f32_16x16x32_bf16 v[56:59], v[104:107], v[96:99], v[56:59]
    ds_read_b128 v[120:123], v13 offset:16384
    ds_read_b128 v[124:127], v13 offset:18432
    v_mfma_f32_16x16x32_bf16 v[72:75], v[104:107], v[100:103], v[72:75]
    ds_read_b128 v[128:131], v13 offset:20480
    ds_read_b128 v[132:135], v13 offset:22528
    v_mfma_f32_16x16x32_bf16 v[28:31], v[108:111], v[88:91], v[28:31]
    ds_read_b64_tr_b16 v[136:137], v14 offset:24576
    ds_read_b64_tr_b16 v[138:139], v14 offset:25600
    v_mfma_f32_16x16x32_bf16 v[44:47], v[108:111], v[92:95], v[44:47]
    ds_read_b64_tr_b16 v[140:141], v15 offset:24576
    ds_read_b64_tr_b16 v[142:143], v15 offset:25600
    v_mfma_f32_16x16x32_bf16 v[60:63], v[108:111], v[96:99], v[60:63]
    ds_read_b64_tr_b16 v[144:145], v16 offset:24576
    ds_read_b64_tr_b16 v[146:147], v16 offset:25600
    v_mfma_f32_16x16x32_bf16 v[76:79], v[108:111], v[100:103], v[76:79]
    ds_read_b64_tr_b16 v[148:149], v17 offset:24576
    ds_read_b64_tr_b16 v[150:151], v17 offset:25600
    v_mfma_f32_16x16x32_bf16 v[32:35], v[112:115], v[88:91], v[32:35]
    v_mfma_f32_16x16x32_bf16 v[48:51], v[112:115], v[92:95], v[48:51]
    v_mfma_f32_16x16x32_bf16 v[64:67], v[112:115], v[96:99], v[64:67]
    v_mfma_f32_16x16x32_bf16 v[80:83], v[112:115], v[100:103], v[80:83]
    v_mfma_f32_16x16x32_bf16 v[36:39], v[116:119], v[88:91], v[36:39]
    v_mfma_f32_16x16x32_bf16 v[52:55], v[116:119], v[92:95], v[52:55]
    v_mfma_f32_16x16x32_bf16 v[68:71], v[116:119], v[96:99], v[68:71]
    v_mfma_f32_16x16x32_bf16 v[84:87], v[116:119], v[100:103], v[84:87]
    s_waitcnt vmcnt(8) lgkmcnt(0)
    s_barrier
    v_mfma_f32_16x16x32_bf16 v[24:27], v[136:139], v[120:123], v[24:27]
    s_add_u32 m0, s35, 73728
    s_nop 0
    buffer_load_dwordx4 v11, s[16:19], s34 offen lds
    v_mfma_f32_16x16x32_bf16 v[40:43], v[136:139], v[124:127], v[40:43]
    buffer_load_dwordx4 v9, s[16:19], s34 offen offset:1024 lds
    s_add_u32 s34, s34, 114688
    v_mfma_f32_16x16x32_bf16 v[56:59], v[136:139], v[128:131], v[56:59]
    ds_read_b128 v[88:91], v12 offset:32768
    ds_read_b128 v[92:95], v12 offset:34816
    v_mfma_f32_16x16x32_bf16 v[72:75], v[136:139], v[132:135], v[72:75]
    ds_read_b128 v[96:99], v12 offset:36864
    ds_read_b128 v[100:103], v12 offset:38912
    v_mfma_f32_16x16x32_bf16 v[28:31], v[140:143], v[120:123], v[28:31]
    ds_read_b64_tr_b16 v[104:105], v14 offset:0
    ds_read_b64_tr_b16 v[106:107], v14 offset:1024
    v_mfma_f32_16x16x32_bf16 v[44:47], v[140:143], v[124:127], v[44:47]
    s_add_u32 m0, s36, 16384
    s_nop 0
    buffer_load_dwordx4 v200, s[12:15], s32 offen offset:0 lds
    v_mfma_f32_16x16x32_bf16 v[60:63], v[140:143], v[128:131], v[60:63]
    buffer_load_dwordx4 v201, s[12:15], s32 offen offset:1024 lds
    buffer_load_dwordx4 v202, s[12:15], s32 offen offset:2048 lds
    v_mfma_f32_16x16x32_bf16 v[76:79], v[140:143], v[132:135], v[76:79]
    buffer_load_dwordx4 v203, s[12:15], s32 offen offset:3072 lds
    s_add_u32 s32, s32, 128
    v_mfma_f32_16x16x32_bf16 v[32:35], v[144:147], v[120:123], v[32:35]
    ds_read_b64_tr_b16 v[108:109], v15 offset:0
    ds_read_b64_tr_b16 v[110:111], v15 offset:1024
    v_mfma_f32_16x16x32_bf16 v[48:51], v[144:147], v[124:127], v[48:51]
    ds_read_b64_tr_b16 v[112:113], v16 offset:0
    ds_read_b64_tr_b16 v[114:115], v16 offset:1024
    v_mfma_f32_16x16x32_bf16 v[64:67], v[144:147], v[128:131], v[64:67]
    ds_read_b64_tr_b16 v[116:117], v17 offset:0
    ds_read_b64_tr_b16 v[118:119], v17 offset:1024
    v_mfma_f32_16x16x32_bf16 v[80:83], v[144:147], v[132:135], v[80:83]
    v_mfma_f32_16x16x32_bf16 v[36:39], v[148:151], v[120:123], v[36:39]
    v_mfma_f32_16x16x32_bf16 v[52:55], v[148:151], v[124:127], v[52:55]
    v_mfma_f32_16x16x32_bf16 v[68:71], v[148:151], v[128:131], v[68:71]
    v_mfma_f32_16x16x32_bf16 v[84:87], v[148:151], v[132:135], v[84:87]
    s_waitcnt vmcnt(12) lgkmcnt(0)
    s_barrier
    v_mfma_f32_16x16x32_bf16 v[24:27], v[104:107], v[88:91], v[24:27]
    s_add_u32 m0, s35, 49152
    s_nop 0
    buffer_load_dwordx4 v11, s[16:19], s34 offen lds
    v_mfma_f32_16x16x32_bf16 v[40:43], v[104:107], v[92:95], v[40:43]
    buffer_load_dwordx4 v9, s[16:19], s34 offen offset:1024 lds
    s_add_u32 s34, s34, 114688
    v_mfma_f32_16x16x32_bf16 v[56:59], v[104:107], v[96:99], v[56:59]
    ds_read_b128 v[120:123], v13 offset:32768
    ds_read_b128 v[124:127], v13 offset:34816
    v_mfma_f32_16x16x32_bf16 v[72:75], v[104:107], v[100:103], v[72:75]
    ds_read_b128 v[128:131], v13 offset:36864
    ds_read_b128 v[132:135], v13 offset:38912
    v_mfma_f32_16x16x32_bf16 v[28:31], v[108:111], v[88:91], v[28:31]
    ds_read_b64_tr_b16 v[136:137], v14 offset:8192
    ds_read_b64_tr_b16 v[138:139], v14 offset:9216
    v_mfma_f32_16x16x32_bf16 v[44:47], v[108:111], v[92:95], v[44:47]
    ds_read_b64_tr_b16 v[140:141], v15 offset:8192
    ds_read_b64_tr_b16 v[142:143], v15 offset:9216
    v_mfma_f32_16x16x32_bf16 v[60:63], v[108:111], v[96:99], v[60:63]
    ds_read_b64_tr_b16 v[144:145], v16 offset:8192
    ds_read_b64_tr_b16 v[146:147], v16 offset:9216
    v_mfma_f32_16x16x32_bf16 v[76:79], v[108:111], v[100:103], v[76:79]
    ds_read_b64_tr_b16 v[148:149], v17 offset:8192
    ds_read_b64_tr_b16 v[150:151], v17 offset:9216
    v_mfma_f32_16x16x32_bf16 v[32:35], v[112:115], v[88:91], v[32:35]
    v_mfma_f32_16x16x32_bf16 v[48:51], v[112:115], v[92:95], v[48:51]
    v_mfma_f32_16x16x32_bf16 v[64:67], v[112:115], v[96:99], v[64:67]
    v_mfma_f32_16x16x32_bf16 v[80:83], v[112:115], v[100:103], v[80:83]
    v_mfma_f32_16x16x32_bf16 v[36:39], v[116:119], v[88:91], v[36:39]
    v_mfma_f32_16x16x32_bf16 v[52:55], v[116:119], v[92:95], v[52:55]
    v_mfma_f32_16x16x32_bf16 v[68:71], v[116:119], v[96:99], v[68:71]
    v_mfma_f32_16x16x32_bf16 v[84:87], v[116:119], v[100:103], v[84:87]
    s_waitcnt vmcnt(8) lgkmcnt(0)
    s_barrier
    v_mfma_f32_16x16x32_bf16 v[24:27], v[136:139], v[120:123], v[24:27]
    s_add_u32 m0, s35, 57344
    s_nop 0
    buffer_load_dwordx4 v11, s[16:19], s34 offen lds
    v_mfma_f32_16x16x32_bf16 v[40:43], v[136:139], v[124:127], v[40:43]
    buffer_load_dwordx4 v9, s[16:19], s34 offen offset:1024 lds
    s_add_u32 s34, s34, 114688
    v_mfma_f32_16x16x32_bf16 v[56:59], v[136:139], v[128:131], v[56:59]
    ds_read_b128 v[88:91], v12 offset:0
    ds_read_b128 v[92:95], v12 offset:2048
    v_mfma_f32_16x16x32_bf16 v[72:75], v[136:139], v[132:135], v[72:75]
    ds_read_b128 v[96:99], v12 offset:4096
    ds_read_b128 v[100:103], v12 offset:6144
    v_mfma_f32_16x16x32_bf16 v[28:31], v[140:143], v[120:123], v[28:31]
    ds_read_b64_tr_b16 v[104:105], v14 offset:16384
    ds_read_b64_tr_b16 v[106:107], v14 offset:17408
    v_mfma_f32_16x16x32_bf16 v[44:47], v[140:143], v[124:127], v[44:47]
    s_add_u32 m0, s36, 32768
    s_nop 0
    buffer_load_dwordx4 v200, s[12:15], s32 offen offset:0 lds
    v_mfma_f32_16x16x32_bf16 v[60:63], v[140:143], v[128:131], v[60:63]
    buffer_load_dwordx4 v201, s[12:15], s32 offen offset:1024 lds
    buffer_load_dwordx4 v202, s[12:15], s32 offen offset:2048 lds
    v_mfma_f32_16x16x32_bf16 v[76:79], v[140:143], v[132:135], v[76:79]
    buffer_load_dwordx4 v203, s[12:15], s32 offen offset:3072 lds
    s_add_u32 s32, s32, 128
    v_mfma_f32_16x16x32_bf16 v[32:35], v[144:147], v[120:123], v[32:35]
    ds_read_b64_tr_b16 v[108:109], v15 offset:16384
    ds_read_b64_tr_b16 v[110:111], v15 offset:17408
    v_mfma_f32_16x16x32_bf16 v[48:51], v[144:147], v[124:127], v[48:51]
    ds_read_b64_tr_b16 v[112:113], v16 offset:16384
    ds_read_b64_tr_b16 v[114:115], v16 offset:17408
    v_mfma_f32_16x16x32_bf16 v[64:67], v[144:147], v[128:131], v[64:67]
    ds_read_b64_tr_b16 v[116:117], v17 offset:16384
    ds_read_b64_tr_b16 v[118:119], v17 offset:17408
    v_mfma_f32_16x16x32_bf16 v[80:83], v[144:147], v[132:135], v[80:83]
    v_mfma_f32_16x16x32_bf16 v[36:39], v[148:151], v[120:123], v[36:39]
    v_mfma_f32_16x16x32_bf16 v[52:55], v[148:151], v[124:127], v[52:55]
    v_mfma_f32_16x16x32_bf16 v[68:71], v[148:151], v[128:131], v[68:71]
    v_mfma_f32_16x16x32_bf16 v[84:87], v[148:151], v[132:135], v[84:87]
    s_waitcnt vmcnt(12) lgkmcnt(0)
    s_barrier
    v_mfma_f32_16x16x32_bf16 v[24:27], v[104:107], v[88:91], v[24:27]
    s_add_u32 m0, s35, 65536
    s_nop 0
    buffer_load_dwordx4 v11, s[16:19], s34 offen lds
    v_mfma_f32_16x16x32_bf16 v[40:43], v[104:107], v[92:95], v[40:43]
    buffer_load_dwordx4 v9, s[16:19], s34 offen offset:1024 lds
    s_add_u32 s34, s34, 114688
    v_mfma_f32_16x16x32_bf16 v[56:59], v[104:107], v[96:99], v[56:59]
    ds_read_b128 v[120:123], v13 offset:0
    ds_read_b128 v[124:127], v13 offset:2048
    v_mfma_f32_16x16x32_bf16 v[72:75], v[104:107], v[100:103], v[72:75]
    ds_read_b128 v[128:131], v13 offset:4096
    ds_read_b128 v[132:135], v13 offset:6144
    v_mfma_f32_16x16x32_bf16 v[28:31], v[108:111], v[88:91], v[28:31]
    ds_read_b64_tr_b16 v[136:137], v14 offset:24576
    ds_read_b64_tr_b16 v[138:139], v14 offset:25600
    v_mfma_f32_16x16x32_bf16 v[44:47], v[108:111], v[92:95], v[44:47]
    ds_read_b64_tr_b16 v[140:141], v15 offset:24576
    ds_read_b64_tr_b16 v[142:143], v15 offset:25600
    v_mfma_f32_16x16x32_bf16 v[60:63], v[108:111], v[96:99], v[60:63]
    ds_read_b64_tr_b16 v[144:145], v16 offset:24576
    ds_read_b64_tr_b16 v[146:147], v16 offset:25600
    v_mfma_f32_16x16x32_bf16 v[76:79], v[108:111], v[100:103], v[76:79]
    ds_read_b64_tr_b16 v[148:149], v17 offset:24576
    ds_read_b64_tr_b16 v[150:151], v17 offset:25600
    v_mfma_f32_16x16x32_bf16 v[32:35], v[112:115], v[88:91], v[32:35]
    v_mfma_f32_16x16x32_bf16 v[48:51], v[112:115], v[92:95], v[48:51]
    v_mfma_f32_16x16x32_bf16 v[64:67], v[112:115], v[96:99], v[64:67]
    v_mfma_f32_16x16x32_bf16 v[80:83], v[112:115], v[100:103], v[80:83]
    v_mfma_f32_16x16x32_bf16 v[36:39], v[116:119], v[88:91], v[36:39]
    v_mfma_f32_16x16x32_bf16 v[52:55], v[116:119], v[92:95], v[52:55]
    v_mfma_f32_16x16x32_bf16 v[68:71], v[116:119], v[96:99], v[68:71]
    v_mfma_f32_16x16x32_bf16 v[84:87], v[116:119], v[100:103], v[84:87]
    s_waitcnt vmcnt(8) lgkmcnt(0)
    s_barrier
    v_mfma_f32_16x16x32_bf16 v[24:27], v[136:139], v[120:123], v[24:27]
    s_add_u32 m0, s35, 73728
    s_nop 0
    buffer_load_dwordx4 v11, s[16:19], s34 offen lds
    v_mfma_f32_16x16x32_bf16 v[40:43], v[136:139], v[124:127], v[40:43]
    buffer_load_dwordx4 v9, s[16:19], s34 offen offset:1024 lds
    s_add_u32 s34, s34, 114688
    v_mfma_f32_16x16x32_bf16 v[56:59], v[136:139], v[128:131], v[56:59]
    ds_read_b128 v[88:91], v12 offset:16384
    ds_read_b128 v[92:95], v12 offset:18432
    v_mfma_f32_16x16x32_bf16 v[72:75], v[136:139], v[132:135], v[72:75]
    ds_read_b128 v[96:99], v12 offset:20480
    ds_read_b128 v[100:103], v12 offset:22528
    v_mfma_f32_16x16x32_bf16 v[28:31], v[140:143], v[120:123], v[28:31]
    ds_read_b64_tr_b16 v[104:105], v14 offset:0
    ds_read_b64_tr_b16 v[106:107], v14 offset:1024
    v_mfma_f32_16x16x32_bf16 v[44:47], v[140:143], v[124:127], v[44:47]
    s_add_u32 m0, s36, 0
    s_nop 0
    buffer_load_dwordx4 v200, s[12:15], s32 offen offset:0 lds
    v_mfma_f32_16x16x32_bf16 v[60:63], v[140:143], v[128:131], v[60:63]
    buffer_load_dwordx4 v201, s[12:15], s32 offen offset:1024 lds
    buffer_load_dwordx4 v202, s[12:15], s32 offen offset:2048 lds
    v_mfma_f32_16x16x32_bf16 v[76:79], v[140:143], v[132:135], v[76:79]
    buffer_load_dwordx4 v203, s[12:15], s32 offen offset:3072 lds
    s_add_u32 s32, s32, 128
    v_mfma_f32_16x16x32_bf16 v[32:35], v[144:147], v[120:123], v[32:35]
    ds_read_b64_tr_b16 v[108:109], v15 offset:0
    ds_read_b64_tr_b16 v[110:111], v15 offset:1024
    v_mfma_f32_16x16x32_bf16 v[48:51], v[144:147], v[124:127], v[48:51]
    ds_read_b64_tr_b16 v[112:113], v16 offset:0
    ds_read_b64_tr_b16 v[114:115], v16 offset:1024
    v_mfma_f32_16x16x32_bf16 v[64:67], v[144:147], v[128:131], v[64:67]
    ds_read_b64_tr_b16 v[116:117], v17 offset:0
    ds_read_b64_tr_b16 v[118:119], v17 offset:1024
    v_mfma_f32_16x16x32_bf16 v[80:83], v[144:147], v[132:135], v[80:83]
    v_mfma_f32_16x16x32_bf16 v[36:39], v[148:151], v[120:123], v[36:39]
    v_mfma_f32_16x16x32_bf16 v[52:55], v[148:151], v[124:127], v[52:55]
    v_mfma_f32_16x16x32_bf16 v[68:71], v[148:151], v[128:131], v[68:71]
    v_mfma_f32_16x16x32_bf16 v[84:87], v[148:151], v[132:135], v[84:87]
    s_waitcnt vmcnt(12) lgkmcnt(0)
    s_barrier
    v_mfma_f32_16x16x32_bf16 v[24:27], v[104:107], v[88:91], v[24:27]
    s_add_u32 m0, s35, 49152
    s_nop 0
    buffer_load_dwordx4 v11, s[16:19], s34 offen lds
    v_mfma_f32_16x16x32_bf16 v[40:43], v[104:107], v[92:95], v[40:43]
    buffer_load_dwordx4 v9, s[16:19], s34 offen offset:1024 lds
    s_add_u32 s34, s34, 114688
    v_mfma_f32_16x16x32_bf16 v[56:59], v[104:107], v[96:99], v[56:59]
    ds_read_b128 v[120:123], v13 offset:16384
    ds_read_b128 v[124:127], v13 offset:18432
    v_mfma_f32_16x16x32_bf16 v[72:75], v[104:107], v[100:103], v[72:75]
    ds_read_b128 v[128:131], v13 offset:20480
    ds_read_b128 v[132:135], v13 offset:22528
    v_mfma_f32_16x16x32_bf16 v[28:31], v[108:111], v[88:91], v[28:31]
    ds_read_b64_tr_b16 v[136:137], v14 offset:8192
    ds_read_b64_tr_b16 v[138:139], v14 offset:9216
    v_mfma_f32_16x16x32_bf16 v[44:47], v[108:111], v[92:95], v[44:47]
    ds_read_b64_tr_b16 v[140:141], v15 offset:8192
    ds_read_b64_tr_b16 v[142:143], v15 offset:9216
    v_mfma_f32_16x16x32_bf16 v[60:63], v[108:111], v[96:99], v[60:63]
    ds_read_b64_tr_b16 v[144:145], v16 offset:8192
    ds_read_b64_tr_b16 v[146:147], v16 offset:9216
    v_mfma_f32_16x16x32_bf16 v[76:79], v[108:111], v[100:103], v[76:79]
    ds_read_b64_tr_b16 v[148:149], v17 offset:8192
    ds_read_b64_tr_b16 v[150:151], v17 offset:9216
    v_mfma_f32_16x16x32_bf16 v[32:35], v[112:115], v[88:91], v[32:35]
    v_mfma_f32_16x16x32_bf16 v[48:51], v[112:115], v[92:95], v[48:51]
    v_mfma_f32_16x16x32_bf16 v[64:67], v[112:115], v[96:99], v[64:67]
    v_mfma_f32_16x16x32_bf16 v[80:83], v[112:115], v[100:103], v[80:83]
    v_mfma_f32_16x16x32_bf16 v[36:39], v[116:119], v[88:91], v[36:39]
    v_mfma_f32_16x16x32_bf16 v[52:55], v[116:119], v[92:95], v[52:55]
    v_mfma_f32_16x16x32_bf16 v[68:71], v[116:119], v[96:99], v[68:71]
    v_mfma_f32_16x16x32_bf16 v[84:87], v[116:119], v[100:103], v[84:87]
    s_waitcnt vmcnt(8) lgkmcnt(0)
    s_barrier
    v_mfma_f32_16x16x32_bf16 v[24:27], v[136:139], v[120:123], v[24:27]
    s_add_u32 m0, s35, 57344
    s_nop 0
    buffer_load_dwordx4 v11, s[16:19], s34 offen lds
    v_mfma_f32_16x16x32_bf16 v[40:43], v[136:139], v[124:127], v[40:43]
    buffer_load_dwordx4 v9, s[16:19], s34 offen offset:1024 lds
    s_add_u32 s34, s34, 114688
    v_mfma_f32_16x16x32_bf16 v[56:59], v[136:139], v[128:131], v[56:59]
    ds_read_b128 v[88:91], v12 offset:32768
    ds_read_b128 v[92:95], v12 offset:34816
    v_mfma_f32_16x16x32_bf16 v[72:75], v[136:139], v[132:135], v[72:75]
    ds_read_b128 v[96:99], v12 offset:36864
    ds_read_b128 v[100:103], v12 offset:38912
    v_mfma_f32_16x16x32_bf16 v[28:31], v[140:143], v[120:123], v[28:31]
    ds_read_b64_tr_b16 v[104:105], v14 offset:16384
    ds_read_b64_tr_b16 v[106:107], v14 offset:17408
    v_mfma_f32_16x16x32_bf16 v[44:47], v[140:143], v[124:127], v[44:47]
    s_add_u32 m0, s36, 16384
    s_nop 0
    buffer_load_dwordx4 v200, s[12:15], s32 offen offset:0 lds
    v_mfma_f32_16x16x32_bf16 v[60:63], v[140:143], v[128:131], v[60:63]
    buffer_load_dwordx4 v201, s[12:15], s32 offen offset:1024 lds
    buffer_load_dwordx4 v202, s[12:15], s32 offen offset:2048 lds
    v_mfma_f32_16x16x32_bf16 v[76:79], v[140:143], v[132:135], v[76:79]
    buffer_load_dwordx4 v203, s[12:15], s32 offen offset:3072 lds
    s_add_u32 s32, s32, 128
    v_mfma_f32_16x16x32_bf16 v[32:35], v[144:147], v[120:123], v[32:35]
    ds_read_b64_tr_b16 v[108:109], v15 offset:16384
    ds_read_b64_tr_b16 v[110:111], v15 offset:17408
    v_mfma_f32_16x16x32_bf16 v[48:51], v[144:147], v[124:127], v[48:51]
    ds_read_b64_tr_b16 v[112:113], v16 offset:16384
    ds_read_b64_tr_b16 v[114:115], v16 offset:17408
    v_mfma_f32_16x16x32_bf16 v[64:67], v[144:147], v[128:131], v[64:67]
    ds_read_b64_tr_b16 v[116:117], v17 offset:16384
    ds_read_b64_tr_b16 v[118:119], v17 offset:17408
    v_mfma_f32_16x16x32_bf16 v[80:83], v[144:147], v[132:135], v[80:83]
    v_mfma_f32_16x16x32_bf16 v[36:39], v[148:151], v[120:123], v[36:39]
    v_mfma_f32_16x16x32_bf16 v[52:55], v[148:151], v[124:127], v[52:55]
    v_mfma_f32_16x16x32_bf16 v[68:71], v[148:151], v[128:131], v[68:71]
    v_mfma_f32_16x16x32_bf16 v[84:87], v[148:151], v[132:135], v[84:87]
    s_waitcnt vmcnt(12) lgkmcnt(0)
    s_barrier
    v_mfma_f32_16x16x32_bf16 v[24:27], v[104:107], v[88:91], v[24:27]
    s_add_u32 m0, s35, 65536
    s_nop 0
    buffer_load_dwordx4 v11, s[16:19], s34 offen lds
    v_mfma_f32_16x16x32_bf16 v[40:43], v[104:107], v[92:95], v[40:43]
    buffer_load_dwordx4 v9, s[16:19], s34 offen offset:1024 lds
    s_add_u32 s34, s34, 114688
    v_mfma_f32_16x16x32_bf16 v[56:59], v[104:107], v[96:99], v[56:59]
    ds_read_b128 v[120:123], v13 offset:32768
    ds_read_b128 v[124:127], v13 offset:34816
    v_mfma_f32_16x16x32_bf16 v[72:75], v[104:107], v[100:103], v[72:75]
    ds_read_b128 v[128:131], v13 offset:36864
    ds_read_b128 v[132:135], v13 offset:38912
    v_mfma_f32_16x16x32_bf16 v[28:31], v[108:111], v[88:91], v[28:31]
    ds_read_b64_tr_b16 v[136:137], v14 offset:24576
    ds_read_b64_tr_b16 v[138:139], v14 offset:25600
    v_mfma_f32_16x16x32_bf16 v[44:47], v[108:111], v[92:95], v[44:47]
    ds_read_b64_tr_b16 v[140:141], v15 offset:24576
    ds_read_b64_tr_b16 v[142:143], v15 offset:25600
    v_mfma_f32_16x16x32_bf16 v[60:63], v[108:111], v[96:99], v[60:63]
    ds_read_b64_tr_b16 v[144:145], v16 offset:24576
    ds_read_b64_tr_b16 v[146:147], v16 offset:25600
    v_mfma_f32_16x16x32_bf16 v[76:79], v[108:111], v[100:103], v[76:79]
    ds_read_b64_tr_b16 v[148:149], v17 offset:24576
    ds_read_b64_tr_b16 v[150:151], v17 offset:25600
    v_mfma_f32_16x16x32_bf16 v[32:35], v[112:115], v[88:91], v[32:35]
    v_mfma_f32_16x16x32_bf16 v[48:51], v[112:115], v[92:95], v[48:51]
    v_mfma_f32_16x16x32_bf16 v[64:67], v[112:115], v[96:99], v[64:67]
    v_mfma_f32_16x16x32_bf16 v[80:83], v[112:115], v[100:103], v[80:83]
    v_mfma_f32_16x16x32_bf16 v[36:39], v[116:119], v[88:91], v[36:39]
    v_mfma_f32_16x16x32_bf16 v[52:55], v[116:119], v[92:95], v[52:55]
    v_mfma_f32_16x16x32_bf16 v[68:71], v[116:119], v[96:99], v[68:71]
    v_mfma_f32_16x16x32_bf16 v[84:87], v[116:119], v[100:103], v[84:87]
    s_waitcnt vmcnt(8) lgkmcnt(0)
    s_barrier
    v_mfma_f32_16x16x32_bf16 v[24:27], v[136:139], v[120:123], v[24:27]
    s_add_u32 m0, s35, 73728
    s_nop 0
    buffer_load_dwordx4 v11, s[16:19], s34 offen lds
    v_mfma_f32_16x16x32_bf16 v[40:43], v[136:139], v[124:127], v[40:43]
    buffer_load_dwordx4 v9, s[16:19], s34 offen offset:1024 lds
    s_add_u32 s34, s34, 114688
    v_mfma_f32_16x16x32_bf16 v[56:59], v[136:139], v[128:131], v[56:59]
    ds_read_b128 v[88:91], v12 offset:0
    ds_read_b128 v[92:95], v12 offset:2048
    v_mfma_f32_16x16x32_bf16 v[72:75], v[136:139], v[132:135], v[72:75]
    ds_read_b128 v[96:99], v12 offset:4096
    ds_read_b128 v[100:103], v12 offset:6144
    v_mfma_f32_16x16x32_bf16 v[28:31], v[140:143], v[120:123], v[28:31]
    ds_read_b64_tr_b16 v[104:105], v14 offset:0
    ds_read_b64_tr_b16 v[106:107], v14 offset:1024
    v_mfma_f32_16x16x32_bf16 v[44:47], v[140:143], v[124:127], v[44:47]
    ds_read_b64_tr_b16 v[108:109], v15 offset:0
    ds_read_b64_tr_b16 v[110:111], v15 offset:1024
    v_mfma_f32_16x16x32_bf16 v[60:63], v[140:143], v[128:131], v[60:63]
    ds_read_b64_tr_b16 v[112:113], v16 offset:0
    ds_read_b64_tr_b16 v[114:115], v16 offset:1024
    v_mfma_f32_16x16x32_bf16 v[76:79], v[140:143], v[132:135], v[76:79]
    ds_read_b64_tr_b16 v[116:117], v17 offset:0
    ds_read_b64_tr_b16 v[118:119], v17 offset:1024
    v_mfma_f32_16x16x32_bf16 v[32:35], v[144:147], v[120:123], v[32:35]
    v_mfma_f32_16x16x32_bf16 v[48:51], v[144:147], v[124:127], v[48:51]
    v_mfma_f32_16x16x32_bf16 v[64:67], v[144:147], v[128:131], v[64:67]
    v_mfma_f32_16x16x32_bf16 v[80:83], v[144:147], v[132:135], v[80:83]
    v_mfma_f32_16x16x32_bf16 v[36:39], v[148:151], v[120:123], v[36:39]
    v_mfma_f32_16x16x32_bf16 v[52:55], v[148:151], v[124:127], v[52:55]
    v_mfma_f32_16x16x32_bf16 v[68:71], v[148:151], v[128:131], v[68:71]
    v_mfma_f32_16x16x32_bf16 v[84:87], v[148:151], v[132:135], v[84:87]
    s_waitcnt vmcnt(8) lgkmcnt(0)
    s_barrier
    v_mfma_f32_16x16x32_bf16 v[24:27], v[104:107], v[88:91], v[24:27]
    ds_read_b128 v[120:123], v13 offset:0
    ds_read_b128 v[124:127], v13 offset:2048
    v_mfma_f32_16x16x32_bf16 v[40:43], v[104:107], v[92:95], v[40:43]
    ds_read_b128 v[128:131], v13 offset:4096
    ds_read_b128 v[132:135], v13 offset:6144
    v_mfma_f32_16x16x32_bf16 v[56:59], v[104:107], v[96:99], v[56:59]
    ds_read_b64_tr_b16 v[136:137], v14 offset:8192
    ds_read_b64_tr_b16 v[138:139], v14 offset:9216
    v_mfma_f32_16x16x32_bf16 v[72:75], v[104:107], v[100:103], v[72:75]
    ds_read_b64_tr_b16 v[140:141], v15 offset:8192
    ds_read_b64_tr_b16 v[142:143], v15 offset:9216
    v_mfma_f32_16x16x32_bf16 v[28:31], v[108:111], v[88:91], v[28:31]
    ds_read_b64_tr_b16 v[144:145], v16 offset:8192
    ds_read_b64_tr_b16 v[146:147], v16 offset:9216
    v_mfma_f32_16x16x32_bf16 v[44:47], v[108:111], v[92:95], v[44:47]
    ds_read_b64_tr_b16 v[148:149], v17 offset:8192
    ds_read_b64_tr_b16 v[150:151], v17 offset:9216
    v_mfma_f32_16x16x32_bf16 v[60:63], v[108:111], v[96:99], v[60:63]
    v_mfma_f32_16x16x32_bf16 v[76:79], v[108:111], v[100:103], v[76:79]
    v_mfma_f32_16x16x32_bf16 v[32:35], v[112:115], v[88:91], v[32:35]
    v_mfma_f32_16x16x32_bf16 v[48:51], v[112:115], v[92:95], v[48:51]
    v_mfma_f32_16x16x32_bf16 v[64:67], v[112:115], v[96:99], v[64:67]
    v_mfma_f32_16x16x32_bf16 v[80:83], v[112:115], v[100:103], v[80:83]
    v_mfma_f32_16x16x32_bf16 v[36:39], v[116:119], v[88:91], v[36:39]
    v_mfma_f32_16x16x32_bf16 v[52:55], v[116:119], v[92:95], v[52:55]
    v_mfma_f32_16x16x32_bf16 v[68:71], v[116:119], v[96:99], v[68:71]
    v_mfma_f32_16x16x32_bf16 v[84:87], v[116:119], v[100:103], v[84:87]
    s_load_dwordx2 s[92:93], s[0:1], 112
    s_load_dwordx2 s[84:85], s[0:1], 120
    s_waitcnt vmcnt(2) lgkmcnt(0)
    s_barrier
    v_mfma_f32_16x16x32_bf16 v[24:27], v[136:139], v[120:123], v[24:27]
    ds_read_b128 v[88:91], v12 offset:16384
    ds_read_b128 v[92:95], v12 offset:18432
    v_mfma_f32_16x16x32_bf16 v[40:43], v[136:139], v[124:127], v[40:43]
    ds_read_b128 v[96:99], v12 offset:20480
    ds_read_b128 v[100:103], v12 offset:22528
    v_mfma_f32_16x16x32_bf16 v[56:59], v[136:139], v[128:131], v[56:59]
    ds_read_b64_tr_b16 v[104:105], v14 offset:16384
    ds_read_b64_tr_b16 v[106:107], v14 offset:17408
    v_mfma_f32_16x16x32_bf16 v[72:75], v[136:139], v[132:135], v[72:75]
    ds_read_b64_tr_b16 v[108:109], v15 offset:16384
    ds_read_b64_tr_b16 v[110:111], v15 offset:17408
    v_mfma_f32_16x16x32_bf16 v[28:31], v[140:143], v[120:123], v[28:31]
    ds_read_b64_tr_b16 v[112:113], v16 offset:16384
    ds_read_b64_tr_b16 v[114:115], v16 offset:17408
    v_mfma_f32_16x16x32_bf16 v[44:47], v[140:143], v[124:127], v[44:47]
    ds_read_b64_tr_b16 v[116:117], v17 offset:16384
    ds_read_b64_tr_b16 v[118:119], v17 offset:17408
    v_mfma_f32_16x16x32_bf16 v[60:63], v[140:143], v[128:131], v[60:63]
    v_mfma_f32_16x16x32_bf16 v[76:79], v[140:143], v[132:135], v[76:79]
    v_mfma_f32_16x16x32_bf16 v[32:35], v[144:147], v[120:123], v[32:35]
    v_mfma_f32_16x16x32_bf16 v[48:51], v[144:147], v[124:127], v[48:51]
    v_mfma_f32_16x16x32_bf16 v[64:67], v[144:147], v[128:131], v[64:67]
    v_mfma_f32_16x16x32_bf16 v[80:83], v[144:147], v[132:135], v[80:83]
    v_mfma_f32_16x16x32_bf16 v[36:39], v[148:151], v[120:123], v[36:39]
    v_mfma_f32_16x16x32_bf16 v[52:55], v[148:151], v[124:127], v[52:55]
    v_mfma_f32_16x16x32_bf16 v[68:71], v[148:151], v[128:131], v[68:71]
    v_mfma_f32_16x16x32_bf16 v[84:87], v[148:151], v[132:135], v[84:87]
    s_waitcnt vmcnt(0) lgkmcnt(0)
    s_barrier
    v_mfma_f32_16x16x32_bf16 v[24:27], v[104:107], v[88:91], v[24:27]
    ds_read_b128 v[120:123], v13 offset:16384
    ds_read_b128 v[124:127], v13 offset:18432
    v_mfma_f32_16x16x32_bf16 v[40:43], v[104:107], v[92:95], v[40:43]
    ds_read_b128 v[128:131], v13 offset:20480
    ds_read_b128 v[132:135], v13 offset:22528
    v_mfma_f32_16x16x32_bf16 v[56:59], v[104:107], v[96:99], v[56:59]
    ds_read_b64_tr_b16 v[136:137], v14 offset:24576
    ds_read_b64_tr_b16 v[138:139], v14 offset:25600
    v_mfma_f32_16x16x32_bf16 v[72:75], v[104:107], v[100:103], v[72:75]
    ds_read_b64_tr_b16 v[140:141], v15 offset:24576
    ds_read_b64_tr_b16 v[142:143], v15 offset:25600
    v_mfma_f32_16x16x32_bf16 v[28:31], v[108:111], v[88:91], v[28:31]
    ds_read_b64_tr_b16 v[144:145], v16 offset:24576
    ds_read_b64_tr_b16 v[146:147], v16 offset:25600
    v_mfma_f32_16x16x32_bf16 v[44:47], v[108:111], v[92:95], v[44:47]
    ds_read_b64_tr_b16 v[148:149], v17 offset:24576
    ds_read_b64_tr_b16 v[150:151], v17 offset:25600
    v_mfma_f32_16x16x32_bf16 v[60:63], v[108:111], v[96:99], v[60:63]
    v_mfma_f32_16x16x32_bf16 v[76:79], v[108:111], v[100:103], v[76:79]
    v_mfma_f32_16x16x32_bf16 v[32:35], v[112:115], v[88:91], v[32:35]
    v_mfma_f32_16x16x32_bf16 v[48:51], v[112:115], v[92:95], v[48:51]
    v_mfma_f32_16x16x32_bf16 v[64:67], v[112:115], v[96:99], v[64:67]
    v_mfma_f32_16x16x32_bf16 v[80:83], v[112:115], v[100:103], v[80:83]
    v_mfma_f32_16x16x32_bf16 v[36:39], v[116:119], v[88:91], v[36:39]
    v_mfma_f32_16x16x32_bf16 v[52:55], v[116:119], v[92:95], v[52:55]
    v_mfma_f32_16x16x32_bf16 v[68:71], v[116:119], v[96:99], v[68:71]
    v_mfma_f32_16x16x32_bf16 v[84:87], v[116:119], v[100:103], v[84:87]
    s_waitcnt lgkmcnt(0)
    v_mfma_f32_16x16x32_bf16 v[24:27], v[136:139], v[120:123], v[24:27]
    v_mfma_f32_16x16x32_bf16 v[40:43], v[136:139], v[124:127], v[40:43]
    v_mfma_f32_16x16x32_bf16 v[56:59], v[136:139], v[128:131], v[56:59]
    v_mfma_f32_16x16x32_bf16 v[72:75], v[136:139], v[132:135], v[72:75]
    v_mfma_f32_16x16x32_bf16 v[28:31], v[140:143], v[120:123], v[28:31]
    v_mfma_f32_16x16x32_bf16 v[44:47], v[140:143], v[124:127], v[44:47]
    v_mfma_f32_16x16x32_bf16 v[60:63], v[140:143], v[128:131], v[60:63]
    v_mfma_f32_16x16x32_bf16 v[76:79], v[140:143], v[132:135], v[76:79]
    v_mfma_f32_16x16x32_bf16 v[32:35], v[144:147], v[120:123], v[32:35]
    v_mfma_f32_16x16x32_bf16 v[48:51], v[144:147], v[124:127], v[48:51]
    v_mfma_f32_16x16x32_bf16 v[64:67], v[144:147], v[128:131], v[64:67]
    v_mfma_f32_16x16x32_bf16 v[80:83], v[144:147], v[132:135], v[80:83]
    v_mfma_f32_16x16x32_bf16 v[36:39], v[148:151], v[120:123], v[36:39]
    v_mfma_f32_16x16x32_bf16 v[52:55], v[148:151], v[124:127], v[52:55]
    v_mfma_f32_16x16x32_bf16 v[68:71], v[148:151], v[128:131], v[68:71]
    v_mfma_f32_16x16x32_bf16 v[84:87], v[148:151], v[132:135], v[84:87]
    s_mov_b32 s94, 256
    s_mov_b32 s95, 0x20000
    s_mov_b32 s86, 6144
    s_mov_b32 s87, 0x20000
    s_add_u32 s84, s84, 0x1120000
    s_addc_u32 s85, s85, 0
    s_cmp_eq_u32 s20, 0
    s_cbranch_scc0 L_g1e
    v_mov_b32 v221, 0
    s_mov_b64 exec, 1
    buffer_load_dword v220, v221, s[92:95], 0 offen sc1
    s_mov_b64 exec, -1
L_g1e:
    v_lshlrev_b32 v14, 4, v1
    s_lshl_b32 s40, s23, 1
    s_add_u32 s40, s40, s37
    s_mul_i32 s41, s40, 56
    s_lshl_b32 s42, s24, 2
    s_add_u32 s41, s41, s42
    s_lshl_b32 s42, s38, 1
    s_add_u32 s41, s41, s42
    s_lshl_b32 s41, s41, 12
    s_add_u32 s43, s41, 4096
    s_mov_b32 s46, 0xbfb8aa3b
    s_mov_b32 s47, s46
    s_mov_b32 s48, 1.0
    s_mov_b32 s49, 1.0
    v_pk_mul_f32 v[124:125], v[24:25], s[46:47]
    v_pk_mul_f32 v[126:127], v[26:27], s[46:47]
    v_exp_f32 v124, v124
    v_exp_f32 v125, v125
    v_exp_f32 v126, v126
    v_exp_f32 v127, v127
    v_pk_add_f32 v[124:125], v[124:125], s[48:49]
    v_pk_add_f32 v[126:127], v[126:127], s[48:49]
    v_rcp_f32 v124, v124
    v_rcp_f32 v125, v125
    v_rcp_f32 v126, v126
    v_rcp_f32 v127, v127
    v_pk_mul_f32 v[24:25], v[24:25], v[124:125]
    v_pk_mul_f32 v[26:27], v[26:27], v[126:127]
    v_cvt_pk_bf16_f32 v88, v24, v25
    v_cvt_pk_bf16_f32 v89, v26, v27
    v_pk_mul_f32 v[128:129], v[28:29], s[46:47]
    v_pk_mul_f32 v[130:131], v[30:31], s[46:47]
    v_exp_f32 v128, v128
    v_exp_f32 v129, v129
    v_exp_f32 v130, v130
    v_exp_f32 v131, v131
    v_pk_add_f32 v[128:129], v[128:129], s[48:49]
    v_pk_add_f32 v[130:131], v[130:131], s[48:49]
    v_rcp_f32 v128, v128
    v_rcp_f32 v129, v129
    v_rcp_f32 v130, v130
    v_rcp_f32 v131, v131
    v_pk_mul_f32 v[28:29], v[28:29], v[128:129]
    v_pk_mul_f32 v[30:31], v[30:31], v[130:131]
    v_cvt_pk_bf16_f32 v90, v28, v29
    v_cvt_pk_bf16_f32 v91, v30, v31
    buffer_store_dwordx4 v[88:91], v14, s[28:31], s41 offen offset:0 sc1
    v_pk_mul_f32 v[124:125], v[40:41], s[46:47]
    v_pk_mul_f32 v[126:127], v[42:43], s[46:47]
    v_exp_f32 v124, v124
    v_exp_f32 v125, v125
    v_exp_f32 v126, v126
    v_exp_f32 v127, v127
    v_pk_add_f32 v[124:125], v[124:125], s[48:49]
    v_pk_add_f32 v[126:127], v[126:127], s[48:49]
    v_rcp_f32 v124, v124
    v_rcp_f32 v125, v125
    v_rcp_f32 v126, v126
    v_rcp_f32 v127, v127
    v_pk_mul_f32 v[40:41], v[40:41], v[124:125]
    v_pk_mul_f32 v[42:43], v[42:43], v[126:127]
    v_cvt_pk_bf16_f32 v92, v40, v41
    v_cvt_pk_bf16_f32 v93, v42, v43
    v_pk_mul_f32 v[128:129], v[44:45], s[46:47]
    v_pk_mul_f32 v[130:131], v[46:47], s[46:47]
    v_exp_f32 v128, v128
    v_exp_f32 v129, v129
    v_exp_f32 v130, v130
    v_exp_f32 v131, v131
    v_pk_add_f32 v[128:129], v[128:129], s[48:49]
    v_pk_add_f32 v[130:131], v[130:131], s[48:49]
    v_rcp_f32 v128, v128
    v_rcp_f32 v129, v129
    v_rcp_f32 v130, v130
    v_rcp_f32 v131, v131
    v_pk_mul_f32 v[44:45], v[44:45], v[128:129]
    v_pk_mul_f32 v[46:47], v[46:47], v[130:131]
    v_cvt_pk_bf16_f32 v94, v44, v45
    v_cvt_pk_bf16_f32 v95, v46, v47
    buffer_store_dwordx4 v[92:95], v14, s[28:31], s41 offen offset:1024 sc1
    v_pk_mul_f32 v[124:125], v[56:57], s[46:47]
    v_pk_mul_f32 v[126:127], v[58:59], s[46:47]
    v_exp_f32 v124, v124
    v_exp_f32 v125, v125
    v_exp_f32 v126, v126
    v_exp_f32 v127, v127
    v_pk_add_f32 v[124:125], v[124:125], s[48:49]
    v_pk_add_f32 v[126:127], v[126:127], s[48:49]
    v_rcp_f32 v124, v124
    v_rcp_f32 v125, v125
    v_rcp_f32 v126, v126
    v_rcp_f32 v127, v127
    v_pk_mul_f32 v[56:57], v[56:57], v[124:125]
    v_pk_mul_f32 v[58:59], v[58:59], v[126:127]
    v_cvt_pk_bf16_f32 v96, v56, v57
    v_cvt_pk_bf16_f32 v97, v58, v59
    v_pk_mul_f32 v[128:129], v[60:61], s[46:47]
    v_pk_mul_f32 v[130:131], v[62:63], s[46:47]
    v_exp_f32 v128, v128
    v_exp_f32 v129, v129
    v_exp_f32 v130, v130
    v_exp_f32 v131, v131
    v_pk_add_f32 v[128:129], v[128:129], s[48:49]
    v_pk_add_f32 v[130:131], v[130:131], s[48:49]
    v_rcp_f32 v128, v128
    v_rcp_f32 v129, v129
    v_rcp_f32 v130, v130
    v_rcp_f32 v131, v131
    v_pk_mul_f32 v[60:61], v[60:61], v[128:129]
    v_pk_mul_f32 v[62:63], v[62:63], v[130:131]
    v_cvt_pk_bf16_f32 v98, v60, v61
    v_cvt_pk_bf16_f32 v99, v62, v63
    buffer_store_dwordx4 v[96:99], v14, s[28:31], s41 offen offset:2048 sc1
    v_pk_mul_f32 v[124:125], v[72:73], s[46:47]
    v_pk_mul_f32 v[126:127], v[74:75], s[46:47]
    v_exp_f32 v124, v124
    v_exp_f32 v125, v125
    v_exp_f32 v126, v126
    v_exp_f32 v127, v127
    v_pk_add_f32 v[124:125], v[124:125], s[48:49]
    v_pk_add_f32 v[126:127], v[126:127], s[48:49]
    v_rcp_f32 v124, v124
    v_rcp_f32 v125, v125
    v_rcp_f32 v126, v126
    v_rcp_f32 v127, v127
    v_pk_mul_f32 v[72:73], v[72:73], v[124:125]
    v_pk_mul_f32 v[74:75], v[74:75], v[126:127]
    v_cvt_pk_bf16_f32 v100, v72, v73
    v_cvt_pk_bf16_f32 v101, v74, v75
    v_pk_mul_f32 v[128:129], v[76:77], s[46:47]
    v_pk_mul_f32 v[130:131], v[78:79], s[46:47]
    v_exp_f32 v128, v128
    v_exp_f32 v129, v129
    v_exp_f32 v130, v130
    v_exp_f32 v131, v131
    v_pk_add_f32 v[128:129], v[128:129], s[48:49]
    v_pk_add_f32 v[130:131], v[130:131], s[48:49]
    v_rcp_f32 v128, v128
    v_rcp_f32 v129, v129
    v_rcp_f32 v130, v130
    v_rcp_f32 v131, v131
    v_pk_mul_f32 v[76:77], v[76:77], v[128:129]
    v_pk_mul_f32 v[78:79], v[78:79], v[130:131]
    v_cvt_pk_bf16_f32 v102, v76, v77
    v_cvt_pk_bf16_f32 v103, v78, v79
    buffer_store_dwordx4 v[100:103], v14, s[28:31], s41 offen offset:3072 sc1
    v_pk_mul_f32 v[124:125], v[32:33], s[46:47]
    v_pk_mul_f32 v[126:127], v[34:35], s[46:47]
    v_exp_f32 v124, v124
    v_exp_f32 v125, v125
    v_exp_f32 v126, v126
    v_exp_f32 v127, v127
    v_pk_add_f32 v[124:125], v[124:125], s[48:49]
    v_pk_add_f32 v[126:127], v[126:127], s[48:49]
    v_rcp_f32 v124, v124
    v_rcp_f32 v125, v125
    v_rcp_f32 v126, v126
    v_rcp_f32 v127, v127
    v_pk_mul_f32 v[32:33], v[32:33], v[124:125]
    v_pk_mul_f32 v[34:35], v[34:35], v[126:127]
    v_cvt_pk_bf16_f32 v104, v32, v33
    v_cvt_pk_bf16_f32 v105, v34, v35
    v_pk_mul_f32 v[128:129], v[36:37], s[46:47]
    v_pk_mul_f32 v[130:131], v[38:39], s[46:47]
    v_exp_f32 v128, v128
    v_exp_f32 v129, v129
    v_exp_f32 v130, v130
    v_exp_f32 v131, v131
    v_pk_add_f32 v[128:129], v[128:129], s[48:49]
    v_pk_add_f32 v[130:131], v[130:131], s[48:49]
    v_rcp_f32 v128, v128
    v_rcp_f32 v129, v129
    v_rcp_f32 v130, v130
    v_rcp_f32 v131, v131
    v_pk_mul_f32 v[36:37], v[36:37], v[128:129]
    v_pk_mul_f32 v[38:39], v[38:39], v[130:131]
    v_cvt_pk_bf16_f32 v106, v36, v37
    v_cvt_pk_bf16_f32 v107, v38, v39
    buffer_store_dwordx4 v[104:107], v14, s[28:31], s43 offen offset:0 sc1
    v_pk_mul_f32 v[124:125], v[48:49], s[46:47]
    v_pk_mul_f32 v[126:127], v[50:51], s[46:47]
    v_exp_f32 v124, v124
    v_exp_f32 v125, v125
    v_exp_f32 v126, v126
    v_exp_f32 v127, v127
    v_pk_add_f32 v[124:125], v[124:125], s[48:49]
    v_pk_add_f32 v[126:127], v[126:127], s[48:49]
    v_rcp_f32 v124, v124
    v_rcp_f32 v125, v125
    v_rcp_f32 v126, v126
    v_rcp_f32 v127, v127
    v_pk_mul_f32 v[48:49], v[48:49], v[124:125]
    v_pk_mul_f32 v[50:51], v[50:51], v[126:127]
    v_cvt_pk_bf16_f32 v108, v48, v49
    v_cvt_pk_bf16_f32 v109, v50, v51
    v_pk_mul_f32 v[128:129], v[52:53], s[46:47]
    v_pk_mul_f32 v[130:131], v[54:55], s[46:47]
    v_exp_f32 v128, v128
    v_exp_f32 v129, v129
    v_exp_f32 v130, v130
    v_exp_f32 v131, v131
    v_pk_add_f32 v[128:129], v[128:129], s[48:49]
    v_pk_add_f32 v[130:131], v[130:131], s[48:49]
    v_rcp_f32 v128, v128
    v_rcp_f32 v129, v129
    v_rcp_f32 v130, v130
    v_rcp_f32 v131, v131
    v_pk_mul_f32 v[52:53], v[52:53], v[128:129]
    v_pk_mul_f32 v[54:55], v[54:55], v[130:131]
    v_cvt_pk_bf16_f32 v110, v52, v53
    v_cvt_pk_bf16_f32 v111, v54, v55
    buffer_store_dwordx4 v[108:111], v14, s[28:31], s43 offen offset:1024 sc1
    v_pk_mul_f32 v[124:125], v[64:65], s[46:47]
    v_pk_mul_f32 v[126:127], v[66:67], s[46:47]
    v_exp_f32 v124, v124
    v_exp_f32 v125, v125
    v_exp_f32 v126, v126
    v_exp_f32 v127, v127
    v_pk_add_f32 v[124:125], v[124:125], s[48:49]
    v_pk_add_f32 v[126:127], v[126:127], s[48:49]
    v_rcp_f32 v124, v124
    v_rcp_f32 v125, v125
    v_rcp_f32 v126, v126
    v_rcp_f32 v127, v127
    v_pk_mul_f32 v[64:65], v[64:65], v[124:125]
    v_pk_mul_f32 v[66:67], v[66:67], v[126:127]
    v_cvt_pk_bf16_f32 v112, v64, v65
    v_cvt_pk_bf16_f32 v113, v66, v67
    v_pk_mul_f32 v[128:129], v[68:69], s[46:47]
    v_pk_mul_f32 v[130:131], v[70:71], s[46:47]
    v_exp_f32 v128, v128
    v_exp_f32 v129, v129
    v_exp_f32 v130, v130
    v_exp_f32 v131, v131
    v_pk_add_f32 v[128:129], v[128:129], s[48:49]
    v_pk_add_f32 v[130:131], v[130:131], s[48:49]
    v_rcp_f32 v128, v128
    v_rcp_f32 v129, v129
    v_rcp_f32 v130, v130
    v_rcp_f32 v131, v131
    v_pk_mul_f32 v[68:69], v[68:69], v[128:129]
    v_pk_mul_f32 v[70:71], v[70:71], v[130:131]
    v_cvt_pk_bf16_f32 v114, v68, v69
    v_cvt_pk_bf16_f32 v115, v70, v71
    buffer_store_dwordx4 v[112:115], v14, s[28:31], s43 offen offset:2048 sc1
    v_pk_mul_f32 v[124:125], v[80:81], s[46:47]
    v_pk_mul_f32 v[126:127], v[82:83], s[46:47]
    v_exp_f32 v124, v124
    v_exp_f32 v125, v125
    v_exp_f32 v126, v126
    v_exp_f32 v127, v127
    v_pk_add_f32 v[124:125], v[124:125], s[48:49]
    v_pk_add_f32 v[126:127], v[126:127], s[48:49]
    v_rcp_f32 v124, v124
    v_rcp_f32 v125, v125
    v_rcp_f32 v126, v126
    v_rcp_f32 v127, v127
    v_pk_mul_f32 v[80:81], v[80:81], v[124:125]
    v_pk_mul_f32 v[82:83], v[82:83], v[126:127]
    v_cvt_pk_bf16_f32 v116, v80, v81
    v_cvt_pk_bf16_f32 v117, v82, v83
    v_pk_mul_f32 v[128:129], v[84:85], s[46:47]
    v_pk_mul_f32 v[130:131], v[86:87], s[46:47]
    v_exp_f32 v128, v128
    v_exp_f32 v129, v129
    v_exp_f32 v130, v130
    v_exp_f32 v131, v131
    v_pk_add_f32 v[128:129], v[128:129], s[48:49]
    v_pk_add_f32 v[130:131], v[130:131], s[48:49]
    v_rcp_f32 v128, v128
    v_rcp_f32 v129, v129
    v_rcp_f32 v130, v130
    v_rcp_f32 v131, v131
    v_pk_mul_f32 v[84:85], v[84:85], v[128:129]
    v_pk_mul_f32 v[86:87], v[86:87], v[130:131]
    v_cvt_pk_bf16_f32 v118, v84, v85
    v_cvt_pk_bf16_f32 v119, v86, v87
    buffer_store_dwordx4 v[116:119], v14, s[28:31], s43 offen offset:3072 sc1
    s_lshl_b32 s50, s23, 8
    s_lshl_b32 s51, s24, 2
    s_add_u32 s50, s50, s51
    s_add_u32 s50, s50, 2048
    s_mov_b64 exec, -1
    s_cmp_eq_u32 s20, 0
    s_cbranch_scc0 L_sb_g1
    v_mov_b32 v60, 0
    s_mov_b64 exec, 1
    s_waitcnt vmcnt(0)
    v_mov_b32 v64, v220
    s_mov_b32 s90, 0
    s_mov_b64 exec, 1
    s_branch L_wc_zg1
L_wp_zg1:
    buffer_load_dword v64, v60, s[92:95], 0 offen sc1
    s_waitcnt vmcnt(0)
L_wc_zg1:
    s_add_u32 s90, s90, 1
    v_cmp_ne_u32 vcc, 1, v64
    s_nop 0
    s_cmp_eq_u64 vcc, 0
    s_cbranch_scc1 L_wg_zg1
    s_cmp_lt_u32 s90, 0x8000
    s_sleep 8
    s_cbranch_scc1 L_wp_zg1
L_wg_zg1:
    s_mov_b64 exec, -1
L_sb_g1:
    s_waitcnt vmcnt(0)
    s_barrier
    s_cmp_eq_u32 s20, 0
    s_cbranch_scc0 L_sig_g1
    v_mov_b32 v60, s50
    v_mov_b32 v61, 1
    s_mov_b64 exec, 1
    buffer_store_dword v61, v60, s[84:87], 0 offen sc1
    s_mov_b64 exec, -1
L_sig_g1:
    s_branch L_gemm2
L_prep:
    s_load_dwordx16 s[4:19], s[0:1], 0
    s_load_dwordx16 s[20:35], s[0:1], 64
    s_mov_b32 s36, s2
    v_lshrrev_b32 v2, 6, v0
    v_and_b32 v1, 63, v0
    v_readfirstlane_b32 s37, v2
    s_nop 0
    s_lshr_b32 s38, s37, 1
    s_and_b32 s39, s37, 1
    s_lshl_b32 s40, s36, 2
    s_lshl_b32 s42, s36, 1
    s_add_u32 s42, s42, s38
    s_lshl_b32 s43, s42, 8
    s_lshl_b32 s60, s39, 7
    s_add_u32 s43, s43, s60
    v_lshl_add_u32 v3, v1, 1, s43
    v_lshlrev_b32 v6, 4, v1
    s_and_b32 s92, s36, 7
    s_lshr_b32 s93, s36, 3
    s_lshl_b32 s78, s92, 8
    s_lshl_b32 s79, s93, 3
    s_add_u32 s78, s78, s79
    s_lshl_b32 s79, s37, 1
    s_add_u32 s78, s78, s79
    s_lshl_b32 s94, s92, 2
    s_lshr_b32 s95, s93, 3
    s_add_u32 s94, s94, s95
    s_and_b32 s95, s93, 7
    s_lshl_b32 s79, s78, 10
    s_waitcnt lgkmcnt(0)
    s_load_dword s41, s[18:19], s40
    global_load_ushort v10, v3, s[6:7]
    global_load_ushort v11, v3, s[8:9]
    global_load_ushort v12, v3, s[10:11]
    global_load_ushort v13, v3, s[12:13]
    global_load_ushort v14, v3, s[14:15]
    global_load_ushort v15, v3, s[16:17]
    s_mov_b32 s64, s4
    s_mov_b32 s65, s5
    s_mov_b32 s66, 0x200000
    s_mov_b32 s67, 0x20000
    s_mov_b32 s68, s26
    s_mov_b32 s69, s27
    s_mov_b32 s70, 0x1c0000
    s_mov_b32 s71, 0x20000
    buffer_load_dwordx4 v[20:23], v6, s[64:67], s79 offen
    buffer_load_dwordx4 v[24:27], v6, s[64:67], s79 offen offset:1024
    global_load_dwordx4 v[28:31], v6, s[28:29]
    s_lshl_b32 s62, s94, 16
    s_lshl_b32 s63, s95, 7
    s_add_u32 s62, s62, s63
    s_lshl_b32 s63, s37, 14
    s_add_u32 s62, s62, s63
    v_lshrrev_b32 v4, 3, v1
    v_lshlrev_b32 v4, 10, v4
    v_and_b32 v5, 7, v1
    v_lshl_add_u32 v4, v5, 4, v4
    s_lshl_b32 s63, s37, 11
    s_add_u32 m0, s63, 0
    s_nop 0
    buffer_load_dwordx4 v4, s[64:67], s62 offen lds
    s_add_u32 s62, s62, 8192
    s_add_u32 m0, s63, 1024
    s_nop 0
    buffer_load_dwordx4 v4, s[64:67], s62 offen lds
    s_lshl_b32 s72, s36, 2
    s_add_u32 s72, s72, s37
    s_cmp_ge_u32 s72, 896
    s_cbranch_scc1 L_prep_now2a
    s_lshr_b32 s73, s72, 4
    s_lshr_b32 s74, s72, 1
    s_and_b32 s74, s74, 7
    s_and_b32 s75, s72, 1
    s_lshl_b32 s76, s73, 15
    s_lshl_b32 s77, s74, 7
    s_add_u32 s76, s76, s77
    s_lshl_b32 s77, s75, 6
    s_add_u32 s76, s76, s77
    v_lshrrev_b32 v5, 2, v1
    v_lshlrev_b32 v5, 10, v5
    v_and_b32 v7, 3, v1
    v_lshl_add_u32 v5, v7, 4, v5
    s_add_u32 m0, s63, 8192
    s_nop 0
    buffer_load_dwordx4 v5, s[68:71], s76 offen lds
    s_add_u32 s76, s76, 16384
    s_add_u32 m0, s63, 9216
    s_nop 0
    buffer_load_dwordx4 v5, s[68:71], s76 offen lds
L_prep_now2a:
    s_add_u32 s44, s34, 0xa00000
    s_addc_u32 s45, s35, 0
    s_mov_b32 s46, 0x410040
    s_mov_b32 s47, 0x20000
    s_add_u32 s48, s34, 0xf00000
    s_addc_u32 s49, s35, 0
    s_mov_b32 s50, 0x200000
    s_mov_b32 s51, 0x20000
    s_add_u32 s52, s34, 0x800000
    s_addc_u32 s53, s35, 0
    s_mov_b32 s54, 0x1c0000
    s_mov_b32 s55, 0x20000
    s_add_u32 s56, s34, 0x1100000
    s_addc_u32 s57, s35, 0
    s_mov_b32 s58, 0x4000
    s_mov_b32 s59, 0x20000
    s_add_u32 s84, s34, 0x1110000
    s_addc_u32 s85, s35, 0
    s_mov_b32 s86, 0x8000
    s_mov_b32 s87, 0x20000
    s_mul_i32 s80, s38, 2112
    s_add_u32 s80, s80, 28688
    v_and_b32 v8, 15, v1
    v_cmp_eq_u32 s[88:89], 15, v8
    v_add_u32 v8, 1, v8
    v_cvt_f32_u32 v8, v8
    v_lshrrev_b32 v9, 4, v1
    s_lshl_b32 s60, s37, 10
    s_add_u32 s60, s60, 16384
    v_lshlrev_b32 v9, 6, v9
    v_add_u32 v9, s60, v9
    v_lshl_add_u32 v7, v1, 4, s60
    v_mov_b32 v64, 0
    v_mov_b32 v65, 0
    v_mov_b32 v66, 0
    v_mov_b32 v67, 0
    v_mov_b32 v68, 0
    v_mov_b32 v69, 0
    v_mov_b32 v70, 0
    v_mov_b32 v71, 0
    v_mov_b32 v72, 0
    v_mov_b32 v73, 0
    v_mov_b32 v74, 0
    v_mov_b32 v75, 0
    v_mov_b32 v76, 0
    v_mov_b32 v77, 0
    v_mov_b32 v78, 0
    v_mov_b32 v79, 0
    s_waitcnt lgkmcnt(0)
    s_lshl_b32 s60, s38, 4
    s_lshr_b32 s41, s41, s60
    s_lshl_b32 s41, s41, 16
    v_mov_b32 v16, s41
    v_mul_f32 v16, 0x3fb8aa3b, v16
    v_exp_f32 v16, v16
    s_nop 0
    v_cvt_pk_bf16_f32 v16, v16, v16
    v_lshlrev_b32 v32, 16, v16
    s_waitcnt vmcnt(5)
    v_lshlrev_b32 v10, 16, v10
    v_lshlrev_b32 v11, 16, v11
    v_lshlrev_b32 v12, 16, v12
    v_lshlrev_b32 v13, 16, v13
    v_lshlrev_b32 v14, 16, v14
    v_lshlrev_b32 v15, 16, v15
    v_mul_f32 v10, v32, v10
    v_mul_f32 v11, v32, v11
    v_mul_f32 v12, v32, v12
    v_mul_f32 v13, v32, v13
    v_mul_f32 v16, 0x3fb8aa3b, v10
    v_mul_f32 v17, 0x3e22f983, v11
    v_mul_f32 v18, v14, v12
    v_fma_f32 v18, -v15, v13, v18
    v_mul_f32 v19, v14, v13
    v_fma_f32 v19, v15, v12, v19
    ds_write_b128 v7, v[16:19]
    s_waitcnt lgkmcnt(0)
    ds_read_b128 v[80:83], v9 offset:0
    ds_read_b128 v[84:87], v9 offset:16
    ds_read_b128 v[88:91], v9 offset:32
    ds_read_b128 v[92:95], v9 offset:48
    v_mov_b32 v10, v18
    s_nop 1
    v_add_f32 v10, v10, v10 row_shr:1 row_mask:0xf bank_mask:0xf bound_ctrl:0
    s_nop 1
    v_add_f32 v10, v10, v10 row_shr:2 row_mask:0xf bank_mask:0xf bound_ctrl:0
    s_nop 1
    v_add_f32 v10, v10, v10 row_shr:4 row_mask:0xf bank_mask:0xf bound_ctrl:0
    s_nop 1
    v_add_f32 v10, v10, v10 row_shr:8 row_mask:0xf bank_mask:0xf bound_ctrl:0
    s_nop 1
    v_add_f32 v10, v10, v10 row_bcast:15 row_mask:0xa bank_mask:0xf
    s_nop 1
    v_add_f32 v10, v10, v10 row_bcast:31 row_mask:0xc bank_mask:0xf
    s_lshl_b32 s61, s37, 2
    s_add_u32 s61, s61, 33024
    v_mov_b32 v11, s61
    v_cmp_eq_u32 vcc, 63, v1
    s_nop 0
    s_and_saveexec_b64 s[90:91], vcc
    ds_write_b32 v11, v10
    s_mov_b64 exec, s[90:91]
    s_waitcnt lgkmcnt(0)
    ds_read_b128 v[152:155], v9 offset:256
    ds_read_b128 v[156:159], v9 offset:272
    ds_read_b128 v[160:163], v9 offset:288
    ds_read_b128 v[164:167], v9 offset:304
    v_mul_f32 v104, v80, v8
    v_mul_f32 v105, v81, v8
    v_mul_f32 v106, v84, v8
    v_mul_f32 v107, v85, v8
    v_mul_f32 v108, v88, v8
    v_mul_f32 v109, v89, v8
    v_mul_f32 v110, v92, v8
    v_mul_f32 v111, v93, v8
    v_exp_f32 v104, v104
    v_fract_f32 v105, v105
    v_exp_f32 v106, v106
    v_fract_f32 v107, v107
    v_exp_f32 v108, v108
    v_fract_f32 v109, v109
    v_exp_f32 v110, v110
    v_fract_f32 v111, v111
    v_cos_f32 v96, v105
    v_sin_f32 v97, v105
    v_cos_f32 v98, v107
    v_sin_f32 v99, v107
    v_cos_f32 v100, v109
    v_sin_f32 v101, v109
    v_cos_f32 v102, v111
    v_sin_f32 v103, v111
    v_pk_mul_f32 v[96:97], v[96:97], v[104:105] op_sel:[0,0] op_sel_hi:[1,0]
    v_pk_mul_f32 v[98:99], v[98:99], v[106:107] op_sel:[0,0] op_sel_hi:[1,0]
    v_pk_mul_f32 v[100:101], v[100:101], v[108:109] op_sel:[0,0] op_sel_hi:[1,0]
    v_pk_mul_f32 v[102:103], v[102:103], v[110:111] op_sel:[0,0] op_sel_hi:[1,0]
    v_cvt_pk_bf16_f32 v120, v96, v97
    v_cvt_pk_bf16_f32 v121, v98, v99
    v_cvt_pk_bf16_f32 v122, v100, v101
    v_cvt_pk_bf16_f32 v123, v102, v103
    v_pk_mul_f32 v[104:105], v[96:97], v[96:97] op_sel:[0,0] op_sel_hi:[0,1]
    v_pk_mul_f32 v[106:107], v[98:99], v[98:99] op_sel:[0,0] op_sel_hi:[0,1]
    v_pk_mul_f32 v[108:109], v[100:101], v[100:101] op_sel:[0,0] op_sel_hi:[0,1]
    v_pk_mul_f32 v[110:111], v[102:103], v[102:103] op_sel:[0,0] op_sel_hi:[0,1]
    v_pk_fma_f32 v[96:97], v[96:97], v[96:97], v[104:105] op_sel:[1,1,0] op_sel_hi:[1,0,1] neg_lo:[1,0,0]
    v_pk_fma_f32 v[98:99], v[98:99], v[98:99], v[106:107] op_sel:[1,1,0] op_sel_hi:[1,0,1] neg_lo:[1,0,0]
    v_pk_fma_f32 v[100:101], v[100:101], v[100:101], v[108:109] op_sel:[1,1,0] op_sel_hi:[1,0,1] neg_lo:[1,0,0]
    v_pk_fma_f32 v[102:103], v[102:103], v[102:103], v[110:111] op_sel:[1,1,0] op_sel_hi:[1,0,1] neg_lo:[1,0,0]
    v_cvt_pk_bf16_f32 v124, v96, v97
    v_cvt_pk_bf16_f32 v125, v98, v99
    v_cvt_pk_bf16_f32 v126, v100, v101
    v_cvt_pk_bf16_f32 v127, v102, v103
    v_pk_mul_f32 v[104:105], v[96:97], v[96:97] op_sel:[0,0] op_sel_hi:[0,1]
    v_pk_mul_f32 v[106:107], v[98:99], v[98:99] op_sel:[0,0] op_sel_hi:[0,1]
    v_pk_mul_f32 v[108:109], v[100:101], v[100:101] op_sel:[0,0] op_sel_hi:[0,1]
    v_pk_mul_f32 v[110:111], v[102:103], v[102:103] op_sel:[0,0] op_sel_hi:[0,1]
    v_pk_fma_f32 v[96:97], v[96:97], v[96:97], v[104:105] op_sel:[1,1,0] op_sel_hi:[1,0,1] neg_lo:[1,0,0]
    v_pk_fma_f32 v[98:99], v[98:99], v[98:99], v[106:107] op_sel:[1,1,0] op_sel_hi:[1,0,1] neg_lo:[1,0,0]
    v_pk_fma_f32 v[100:101], v[100:101], v[100:101], v[108:109] op_sel:[1,1,0] op_sel_hi:[1,0,1] neg_lo:[1,0,0]
    v_pk_fma_f32 v[102:103], v[102:103], v[102:103], v[110:111] op_sel:[1,1,0] op_sel_hi:[1,0,1] neg_lo:[1,0,0]
    v_cvt_pk_bf16_f32 v128, v96, v97
    v_cvt_pk_bf16_f32 v129, v98, v99
    v_cvt_pk_bf16_f32 v130, v100, v101
    v_cvt_pk_bf16_f32 v131, v102, v103
    v_pk_mul_f32 v[104:105], v[96:97], v[96:97] op_sel:[0,0] op_sel_hi:[0,1]
    v_pk_mul_f32 v[106:107], v[98:99], v[98:99] op_sel:[0,0] op_sel_hi:[0,1]
    v_pk_mul_f32 v[108:109], v[100:101], v[100:101] op_sel:[0,0] op_sel_hi:[0,1]
    v_pk_mul_f32 v[110:111], v[102:103], v[102:103] op_sel:[0,0] op_sel_hi:[0,1]
    v_pk_fma_f32 v[96:97], v[96:97], v[96:97], v[104:105] op_sel:[1,1,0] op_sel_hi:[1,0,1] neg_lo:[1,0,0]
    v_pk_fma_f32 v[98:99], v[98:99], v[98:99], v[106:107] op_sel:[1,1,0] op_sel_hi:[1,0,1] neg_lo:[1,0,0]
    v_pk_fma_f32 v[100:101], v[100:101], v[100:101], v[108:109] op_sel:[1,1,0] op_sel_hi:[1,0,1] neg_lo:[1,0,0]
    v_pk_fma_f32 v[102:103], v[102:103], v[102:103], v[110:111] op_sel:[1,1,0] op_sel_hi:[1,0,1] neg_lo:[1,0,0]
    v_cvt_pk_bf16_f32 v132, v96, v97
    v_cvt_pk_bf16_f32 v133, v98, v99
    v_cvt_pk_bf16_f32 v134, v100, v101
    v_cvt_pk_bf16_f32 v135, v102, v103
    v_pk_mul_f32 v[104:105], v[96:97], v[96:97] op_sel:[0,0] op_sel_hi:[0,1]
    v_pk_mul_f32 v[106:107], v[98:99], v[98:99] op_sel:[0,0] op_sel_hi:[0,1]
    v_pk_mul_f32 v[108:109], v[100:101], v[100:101] op_sel:[0,0] op_sel_hi:[0,1]
    v_pk_mul_f32 v[110:111], v[102:103], v[102:103] op_sel:[0,0] op_sel_hi:[0,1]
    v_pk_fma_f32 v[96:97], v[96:97], v[96:97], v[104:105] op_sel:[1,1,0] op_sel_hi:[1,0,1] neg_lo:[1,0,0]
    v_pk_fma_f32 v[98:99], v[98:99], v[98:99], v[106:107] op_sel:[1,1,0] op_sel_hi:[1,0,1] neg_lo:[1,0,0]
    v_pk_fma_f32 v[100:101], v[100:101], v[100:101], v[108:109] op_sel:[1,1,0] op_sel_hi:[1,0,1] neg_lo:[1,0,0]
    v_pk_fma_f32 v[102:103], v[102:103], v[102:103], v[110:111] op_sel:[1,1,0] op_sel_hi:[1,0,1] neg_lo:[1,0,0]
    v_pk_mul_f32 v[104:105], v[82:83], v[96:97] op_sel:[0,0] op_sel_hi:[0,1]
    v_pk_mul_f32 v[106:107], v[86:87], v[98:99] op_sel:[0,0] op_sel_hi:[0,1]
    v_pk_mul_f32 v[108:109], v[90:91], v[100:101] op_sel:[0,0] op_sel_hi:[0,1]
    v_pk_mul_f32 v[110:111], v[94:95], v[102:103] op_sel:[0,0] op_sel_hi:[0,1]
    v_pk_fma_f32 v[112:113], v[82:83], v[96:97], v[104:105] op_sel:[1,1,0] op_sel_hi:[1,0,1] neg_lo:[1,0,0]
    v_pk_fma_f32 v[114:115], v[86:87], v[98:99], v[106:107] op_sel:[1,1,0] op_sel_hi:[1,0,1] neg_lo:[1,0,0]
    v_pk_fma_f32 v[116:117], v[90:91], v[100:101], v[108:109] op_sel:[1,1,0] op_sel_hi:[1,0,1] neg_lo:[1,0,0]
    v_pk_fma_f32 v[118:119], v[94:95], v[102:103], v[110:111] op_sel:[1,1,0] op_sel_hi:[1,0,1] neg_lo:[1,0,0]
    v_cndmask_b32 v112, v112, v82, s[88:89]
    v_cndmask_b32 v113, v113, v83, s[88:89]
    v_cndmask_b32 v114, v114, v86, s[88:89]
    v_cndmask_b32 v115, v115, v87, s[88:89]
    v_cndmask_b32 v116, v116, v90, s[88:89]
    v_cndmask_b32 v117, v117, v91, s[88:89]
    v_cndmask_b32 v118, v118, v94, s[88:89]
    v_cndmask_b32 v119, v119, v95, s[88:89]
    v_cvt_pk_bf16_f32 v136, v112, -v113
    v_cvt_pk_bf16_f32 v137, v114, -v115
    v_cvt_pk_bf16_f32 v138, v116, -v117
    v_cvt_pk_bf16_f32 v139, v118, -v119
    v_pk_mul_f32 v[104:105], v[96:97], v[96:97] op_sel:[0,0] op_sel_hi:[0,1]
    v_pk_mul_f32 v[106:107], v[98:99], v[98:99] op_sel:[0,0] op_sel_hi:[0,1]
    v_pk_mul_f32 v[108:109], v[100:101], v[100:101] op_sel:[0,0] op_sel_hi:[0,1]
    v_pk_mul_f32 v[110:111], v[102:103], v[102:103] op_sel:[0,0] op_sel_hi:[0,1]
    v_pk_fma_f32 v[96:97], v[96:97], v[96:97], v[104:105] op_sel:[1,1,0] op_sel_hi:[1,0,1] neg_lo:[1,0,0]
    v_pk_fma_f32 v[98:99], v[98:99], v[98:99], v[106:107] op_sel:[1,1,0] op_sel_hi:[1,0,1] neg_lo:[1,0,0]
    v_pk_fma_f32 v[100:101], v[100:101], v[100:101], v[108:109] op_sel:[1,1,0] op_sel_hi:[1,0,1] neg_lo:[1,0,0]
    v_pk_fma_f32 v[102:103], v[102:103], v[102:103], v[110:111] op_sel:[1,1,0] op_sel_hi:[1,0,1] neg_lo:[1,0,0]
    v_pk_mul_f32 v[104:105], v[82:83], v[96:97] op_sel:[0,0] op_sel_hi:[0,1]
    v_pk_mul_f32 v[106:107], v[86:87], v[98:99] op_sel:[0,0] op_sel_hi:[0,1]
    v_pk_mul_f32 v[108:109], v[90:91], v[100:101] op_sel:[0,0] op_sel_hi:[0,1]
    v_pk_mul_f32 v[110:111], v[94:95], v[102:103] op_sel:[0,0] op_sel_hi:[0,1]
    v_pk_fma_f32 v[112:113], v[82:83], v[96:97], v[104:105] op_sel:[1,1,0] op_sel_hi:[1,0,1] neg_lo:[1,0,0]
    v_pk_fma_f32 v[114:115], v[86:87], v[98:99], v[106:107] op_sel:[1,1,0] op_sel_hi:[1,0,1] neg_lo:[1,0,0]
    v_pk_fma_f32 v[116:117], v[90:91], v[100:101], v[108:109] op_sel:[1,1,0] op_sel_hi:[1,0,1] neg_lo:[1,0,0]
    v_pk_fma_f32 v[118:119], v[94:95], v[102:103], v[110:111] op_sel:[1,1,0] op_sel_hi:[1,0,1] neg_lo:[1,0,0]
    v_cvt_pk_bf16_f32 v140, v112, -v113
    v_cvt_pk_bf16_f32 v141, v114, -v115
    v_cvt_pk_bf16_f32 v142, v116, -v117
    v_cvt_pk_bf16_f32 v143, v118, -v119
    v_pk_mul_f32 v[104:105], v[96:97], v[96:97] op_sel:[0,0] op_sel_hi:[0,1]
    v_pk_mul_f32 v[106:107], v[98:99], v[98:99] op_sel:[0,0] op_sel_hi:[0,1]
    v_pk_mul_f32 v[108:109], v[100:101], v[100:101] op_sel:[0,0] op_sel_hi:[0,1]
    v_pk_mul_f32 v[110:111], v[102:103], v[102:103] op_sel:[0,0] op_sel_hi:[0,1]
    v_pk_fma_f32 v[96:97], v[96:97], v[96:97], v[104:105] op_sel:[1,1,0] op_sel_hi:[1,0,1] neg_lo:[1,0,0]
    v_pk_fma_f32 v[98:99], v[98:99], v[98:99], v[106:107] op_sel:[1,1,0] op_sel_hi:[1,0,1] neg_lo:[1,0,0]
    v_pk_fma_f32 v[100:101], v[100:101], v[100:101], v[108:109] op_sel:[1,1,0] op_sel_hi:[1,0,1] neg_lo:[1,0,0]
    v_pk_fma_f32 v[102:103], v[102:103], v[102:103], v[110:111] op_sel:[1,1,0] op_sel_hi:[1,0,1] neg_lo:[1,0,0]
    v_pk_mul_f32 v[104:105], v[82:83], v[96:97] op_sel:[0,0] op_sel_hi:[0,1]
    v_pk_mul_f32 v[106:107], v[86:87], v[98:99] op_sel:[0,0] op_sel_hi:[0,1]
    v_pk_mul_f32 v[108:109], v[90:91], v[100:101] op_sel:[0,0] op_sel_hi:[0,1]
    v_pk_mul_f32 v[110:111], v[94:95], v[102:103] op_sel:[0,0] op_sel_hi:[0,1]
    v_pk_fma_f32 v[112:113], v[82:83], v[96:97], v[104:105] op_sel:[1,1,0] op_sel_hi:[1,0,1] neg_lo:[1,0,0]
    v_pk_fma_f32 v[114:115], v[86:87], v[98:99], v[106:107] op_sel:[1,1,0] op_sel_hi:[1,0,1] neg_lo:[1,0,0]
    v_pk_fma_f32 v[116:117], v[90:91], v[100:101], v[108:109] op_sel:[1,1,0] op_sel_hi:[1,0,1] neg_lo:[1,0,0]
    v_pk_fma_f32 v[118:119], v[94:95], v[102:103], v[110:111] op_sel:[1,1,0] op_sel_hi:[1,0,1] neg_lo:[1,0,0]
    v_cvt_pk_bf16_f32 v144, v112, -v113
    v_cvt_pk_bf16_f32 v145, v114, -v115
    v_cvt_pk_bf16_f32 v146, v116, -v117
    v_cvt_pk_bf16_f32 v147, v118, -v119
    v_pk_mul_f32 v[104:105], v[96:97], v[96:97] op_sel:[0,0] op_sel_hi:[0,1]
    v_pk_mul_f32 v[106:107], v[98:99], v[98:99] op_sel:[0,0] op_sel_hi:[0,1]
    v_pk_mul_f32 v[108:109], v[100:101], v[100:101] op_sel:[0,0] op_sel_hi:[0,1]
    v_pk_mul_f32 v[110:111], v[102:103], v[102:103] op_sel:[0,0] op_sel_hi:[0,1]
    v_pk_fma_f32 v[96:97], v[96:97], v[96:97], v[104:105] op_sel:[1,1,0] op_sel_hi:[1,0,1] neg_lo:[1,0,0]
    v_pk_fma_f32 v[98:99], v[98:99], v[98:99], v[106:107] op_sel:[1,1,0] op_sel_hi:[1,0,1] neg_lo:[1,0,0]
    v_pk_fma_f32 v[100:101], v[100:101], v[100:101], v[108:109] op_sel:[1,1,0] op_sel_hi:[1,0,1] neg_lo:[1,0,0]
    v_pk_fma_f32 v[102:103], v[102:103], v[102:103], v[110:111] op_sel:[1,1,0] op_sel_hi:[1,0,1] neg_lo:[1,0,0]
    v_pk_mul_f32 v[104:105], v[82:83], v[96:97] op_sel:[0,0] op_sel_hi:[0,1]
    v_pk_mul_f32 v[106:107], v[86:87], v[98:99] op_sel:[0,0] op_sel_hi:[0,1]
    v_pk_mul_f32 v[108:109], v[90:91], v[100:101] op_sel:[0,0] op_sel_hi:[0,1]
    v_pk_mul_f32 v[110:111], v[94:95], v[102:103] op_sel:[0,0] op_sel_hi:[0,1]
    v_pk_fma_f32 v[112:113], v[82:83], v[96:97], v[104:105] op_sel:[1,1,0] op_sel_hi:[1,0,1] neg_lo:[1,0,0]
    v_pk_fma_f32 v[114:115], v[86:87], v[98:99], v[106:107] op_sel:[1,1,0] op_sel_hi:[1,0,1] neg_lo:[1,0,0]
    v_pk_fma_f32 v[116:117], v[90:91], v[100:101], v[108:109] op_sel:[1,1,0] op_sel_hi:[1,0,1] neg_lo:[1,0,0]
    v_pk_fma_f32 v[118:119], v[94:95], v[102:103], v[110:111] op_sel:[1,1,0] op_sel_hi:[1,0,1] neg_lo:[1,0,0]
    v_cvt_pk_bf16_f32 v148, v112, -v113
    v_cvt_pk_bf16_f32 v149, v114, -v115
    v_cvt_pk_bf16_f32 v150, v116, -v117
    v_cvt_pk_bf16_f32 v151, v118, -v119
    v_mfma_f32_16x16x32_bf16 v[64:67], v[136:139], v[120:123], v[64:67]
    v_mfma_f32_16x16x32_bf16 v[68:71], v[140:143], v[124:127], v[68:71]
    v_mfma_f32_16x16x32_bf16 v[72:75], v[144:147], v[128:131], v[72:75]
    v_mfma_f32_16x16x32_bf16 v[76:79], v[148:151], v[132:135], v[76:79]
    s_waitcnt lgkmcnt(0)
    ds_read_b128 v[80:83], v9 offset:512
    ds_read_b128 v[84:87], v9 offset:528
    ds_read_b128 v[88:91], v9 offset:544
    ds_read_b128 v[92:95], v9 offset:560
    v_mul_f32 v104, v152, v8
    v_mul_f32 v105, v153, v8
    v_mul_f32 v106, v156, v8
    v_mul_f32 v107, v157, v8
    v_mul_f32 v108, v160, v8
    v_mul_f32 v109, v161, v8
    v_mul_f32 v110, v164, v8
    v_mul_f32 v111, v165, v8
    v_exp_f32 v104, v104
    v_fract_f32 v105, v105
    v_exp_f32 v106, v106
    v_fract_f32 v107, v107
    v_exp_f32 v108, v108
    v_fract_f32 v109, v109
    v_exp_f32 v110, v110
    v_fract_f32 v111, v111
    v_cos_f32 v96, v105
    v_sin_f32 v97, v105
    v_cos_f32 v98, v107
    v_sin_f32 v99, v107
    v_cos_f32 v100, v109
    v_sin_f32 v101, v109
    v_cos_f32 v102, v111
    v_sin_f32 v103, v111
    v_pk_mul_f32 v[96:97], v[96:97], v[104:105] op_sel:[0,0] op_sel_hi:[1,0]
    v_pk_mul_f32 v[98:99], v[98:99], v[106:107] op_sel:[0,0] op_sel_hi:[1,0]
    v_pk_mul_f32 v[100:101], v[100:101], v[108:109] op_sel:[0,0] op_sel_hi:[1,0]
    v_pk_mul_f32 v[102:103], v[102:103], v[110:111] op_sel:[0,0] op_sel_hi:[1,0]
    v_cvt_pk_bf16_f32 v120, v96, v97
    v_cvt_pk_bf16_f32 v121, v98, v99
    v_cvt_pk_bf16_f32 v122, v100, v101
    v_cvt_pk_bf16_f32 v123, v102, v103
    v_pk_mul_f32 v[104:105], v[96:97], v[96:97] op_sel:[0,0] op_sel_hi:[0,1]
    v_pk_mul_f32 v[106:107], v[98:99], v[98:99] op_sel:[0,0] op_sel_hi:[0,1]
    v_pk_mul_f32 v[108:109], v[100:101], v[100:101] op_sel:[0,0] op_sel_hi:[0,1]
    v_pk_mul_f32 v[110:111], v[102:103], v[102:103] op_sel:[0,0] op_sel_hi:[0,1]
    v_pk_fma_f32 v[96:97], v[96:97], v[96:97], v[104:105] op_sel:[1,1,0] op_sel_hi:[1,0,1] neg_lo:[1,0,0]
    v_pk_fma_f32 v[98:99], v[98:99], v[98:99], v[106:107] op_sel:[1,1,0] op_sel_hi:[1,0,1] neg_lo:[1,0,0]
    v_pk_fma_f32 v[100:101], v[100:101], v[100:101], v[108:109] op_sel:[1,1,0] op_sel_hi:[1,0,1] neg_lo:[1,0,0]
    v_pk_fma_f32 v[102:103], v[102:103], v[102:103], v[110:111] op_sel:[1,1,0] op_sel_hi:[1,0,1] neg_lo:[1,0,0]
    v_cvt_pk_bf16_f32 v124, v96, v97
    v_cvt_pk_bf16_f32 v125, v98, v99
    v_cvt_pk_bf16_f32 v126, v100, v101
    v_cvt_pk_bf16_f32 v127, v102, v103
    v_pk_mul_f32 v[104:105], v[96:97], v[96:97] op_sel:[0,0] op_sel_hi:[0,1]
    v_pk_mul_f32 v[106:107], v[98:99], v[98:99] op_sel:[0,0] op_sel_hi:[0,1]
    v_pk_mul_f32 v[108:109], v[100:101], v[100:101] op_sel:[0,0] op_sel_hi:[0,1]
    v_pk_mul_f32 v[110:111], v[102:103], v[102:103] op_sel:[0,0] op_sel_hi:[0,1]
    v_pk_fma_f32 v[96:97], v[96:97], v[96:97], v[104:105] op_sel:[1,1,0] op_sel_hi:[1,0,1] neg_lo:[1,0,0]
    v_pk_fma_f32 v[98:99], v[98:99], v[98:99], v[106:107] op_sel:[1,1,0] op_sel_hi:[1,0,1] neg_lo:[1,0,0]
    v_pk_fma_f32 v[100:101], v[100:101], v[100:101], v[108:109] op_sel:[1,1,0] op_sel_hi:[1,0,1] neg_lo:[1,0,0]
    v_pk_fma_f32 v[102:103], v[102:103], v[102:103], v[110:111] op_sel:[1,1,0] op_sel_hi:[1,0,1] neg_lo:[1,0,0]
    v_cvt_pk_bf16_f32 v128, v96, v97
    v_cvt_pk_bf16_f32 v129, v98, v99
    v_cvt_pk_bf16_f32 v130, v100, v101
    v_cvt_pk_bf16_f32 v131, v102, v103
    v_pk_mul_f32 v[104:105], v[96:97], v[96:97] op_sel:[0,0] op_sel_hi:[0,1]
    v_pk_mul_f32 v[106:107], v[98:99], v[98:99] op_sel:[0,0] op_sel_hi:[0,1]
    v_pk_mul_f32 v[108:109], v[100:101], v[100:101] op_sel:[0,0] op_sel_hi:[0,1]
    v_pk_mul_f32 v[110:111], v[102:103], v[102:103] op_sel:[0,0] op_sel_hi:[0,1]
    v_pk_fma_f32 v[96:97], v[96:97], v[96:97], v[104:105] op_sel:[1,1,0] op_sel_hi:[1,0,1] neg_lo:[1,0,0]
    v_pk_fma_f32 v[98:99], v[98:99], v[98:99], v[106:107] op_sel:[1,1,0] op_sel_hi:[1,0,1] neg_lo:[1,0,0]
    v_pk_fma_f32 v[100:101], v[100:101], v[100:101], v[108:109] op_sel:[1,1,0] op_sel_hi:[1,0,1] neg_lo:[1,0,0]
    v_pk_fma_f32 v[102:103], v[102:103], v[102:103], v[110:111] op_sel:[1,1,0] op_sel_hi:[1,0,1] neg_lo:[1,0,0]
    v_cvt_pk_bf16_f32 v132, v96, v97
    v_cvt_pk_bf16_f32 v133, v98, v99
    v_cvt_pk_bf16_f32 v134, v100, v101
    v_cvt_pk_bf16_f32 v135, v102, v103
    v_pk_mul_f32 v[104:105], v[96:97], v[96:97] op_sel:[0,0] op_sel_hi:[0,1]
    v_pk_mul_f32 v[106:107], v[98:99], v[98:99] op_sel:[0,0] op_sel_hi:[0,1]
    v_pk_mul_f32 v[108:109], v[100:101], v[100:101] op_sel:[0,0] op_sel_hi:[0,1]
    v_pk_mul_f32 v[110:111], v[102:103], v[102:103] op_sel:[0,0] op_sel_hi:[0,1]
    v_pk_fma_f32 v[96:97], v[96:97], v[96:97], v[104:105] op_sel:[1,1,0] op_sel_hi:[1,0,1] neg_lo:[1,0,0]
    v_pk_fma_f32 v[98:99], v[98:99], v[98:99], v[106:107] op_sel:[1,1,0] op_sel_hi:[1,0,1] neg_lo:[1,0,0]
    v_pk_fma_f32 v[100:101], v[100:101], v[100:101], v[108:109] op_sel:[1,1,0] op_sel_hi:[1,0,1] neg_lo:[1,0,0]
    v_pk_fma_f32 v[102:103], v[102:103], v[102:103], v[110:111] op_sel:[1,1,0] op_sel_hi:[1,0,1] neg_lo:[1,0,0]
    v_pk_mul_f32 v[104:105], v[154:155], v[96:97] op_sel:[0,0] op_sel_hi:[0,1]
    v_pk_mul_f32 v[106:107], v[158:159], v[98:99] op_sel:[0,0] op_sel_hi:[0,1]
    v_pk_mul_f32 v[108:109], v[162:163], v[100:101] op_sel:[0,0] op_sel_hi:[0,1]
    v_pk_mul_f32 v[110:111], v[166:167], v[102:103] op_sel:[0,0] op_sel_hi:[0,1]
    v_pk_fma_f32 v[112:113], v[154:155], v[96:97], v[104:105] op_sel:[1,1,0] op_sel_hi:[1,0,1] neg_lo:[1,0,0]
    v_pk_fma_f32 v[114:115], v[158:159], v[98:99], v[106:107] op_sel:[1,1,0] op_sel_hi:[1,0,1] neg_lo:[1,0,0]
    v_pk_fma_f32 v[116:117], v[162:163], v[100:101], v[108:109] op_sel:[1,1,0] op_sel_hi:[1,0,1] neg_lo:[1,0,0]
    v_pk_fma_f32 v[118:119], v[166:167], v[102:103], v[110:111] op_sel:[1,1,0] op_sel_hi:[1,0,1] neg_lo:[1,0,0]
    v_cndmask_b32 v112, v112, v154, s[88:89]
    v_cndmask_b32 v113, v113, v155, s[88:89]
    v_cndmask_b32 v114, v114, v158, s[88:89]
    v_cndmask_b32 v115, v115, v159, s[88:89]
    v_cndmask_b32 v116, v116, v162, s[88:89]
    v_cndmask_b32 v117, v117, v163, s[88:89]
    v_cndmask_b32 v118, v118, v166, s[88:89]
    v_cndmask_b32 v119, v119, v167, s[88:89]
    v_cvt_pk_bf16_f32 v136, v112, -v113
    v_cvt_pk_bf16_f32 v137, v114, -v115
    v_cvt_pk_bf16_f32 v138, v116, -v117
    v_cvt_pk_bf16_f32 v139, v118, -v119
    v_pk_mul_f32 v[104:105], v[96:97], v[96:97] op_sel:[0,0] op_sel_hi:[0,1]
    v_pk_mul_f32 v[106:107], v[98:99], v[98:99] op_sel:[0,0] op_sel_hi:[0,1]
    v_pk_mul_f32 v[108:109], v[100:101], v[100:101] op_sel:[0,0] op_sel_hi:[0,1]
    v_pk_mul_f32 v[110:111], v[102:103], v[102:103] op_sel:[0,0] op_sel_hi:[0,1]
    v_pk_fma_f32 v[96:97], v[96:97], v[96:97], v[104:105] op_sel:[1,1,0] op_sel_hi:[1,0,1] neg_lo:[1,0,0]
    v_pk_fma_f32 v[98:99], v[98:99], v[98:99], v[106:107] op_sel:[1,1,0] op_sel_hi:[1,0,1] neg_lo:[1,0,0]
    v_pk_fma_f32 v[100:101], v[100:101], v[100:101], v[108:109] op_sel:[1,1,0] op_sel_hi:[1,0,1] neg_lo:[1,0,0]
    v_pk_fma_f32 v[102:103], v[102:103], v[102:103], v[110:111] op_sel:[1,1,0] op_sel_hi:[1,0,1] neg_lo:[1,0,0]
    v_pk_mul_f32 v[104:105], v[154:155], v[96:97] op_sel:[0,0] op_sel_hi:[0,1]
    v_pk_mul_f32 v[106:107], v[158:159], v[98:99] op_sel:[0,0] op_sel_hi:[0,1]
    v_pk_mul_f32 v[108:109], v[162:163], v[100:101] op_sel:[0,0] op_sel_hi:[0,1]
    v_pk_mul_f32 v[110:111], v[166:167], v[102:103] op_sel:[0,0] op_sel_hi:[0,1]
    v_pk_fma_f32 v[112:113], v[154:155], v[96:97], v[104:105] op_sel:[1,1,0] op_sel_hi:[1,0,1] neg_lo:[1,0,0]
    v_pk_fma_f32 v[114:115], v[158:159], v[98:99], v[106:107] op_sel:[1,1,0] op_sel_hi:[1,0,1] neg_lo:[1,0,0]
    v_pk_fma_f32 v[116:117], v[162:163], v[100:101], v[108:109] op_sel:[1,1,0] op_sel_hi:[1,0,1] neg_lo:[1,0,0]
    v_pk_fma_f32 v[118:119], v[166:167], v[102:103], v[110:111] op_sel:[1,1,0] op_sel_hi:[1,0,1] neg_lo:[1,0,0]
    v_cvt_pk_bf16_f32 v140, v112, -v113
    v_cvt_pk_bf16_f32 v141, v114, -v115
    v_cvt_pk_bf16_f32 v142, v116, -v117
    v_cvt_pk_bf16_f32 v143, v118, -v119
    v_pk_mul_f32 v[104:105], v[96:97], v[96:97] op_sel:[0,0] op_sel_hi:[0,1]
    v_pk_mul_f32 v[106:107], v[98:99], v[98:99] op_sel:[0,0] op_sel_hi:[0,1]
    v_pk_mul_f32 v[108:109], v[100:101], v[100:101] op_sel:[0,0] op_sel_hi:[0,1]
    v_pk_mul_f32 v[110:111], v[102:103], v[102:103] op_sel:[0,0] op_sel_hi:[0,1]
    v_pk_fma_f32 v[96:97], v[96:97], v[96:97], v[104:105] op_sel:[1,1,0] op_sel_hi:[1,0,1] neg_lo:[1,0,0]
    v_pk_fma_f32 v[98:99], v[98:99], v[98:99], v[106:107] op_sel:[1,1,0] op_sel_hi:[1,0,1] neg_lo:[1,0,0]
    v_pk_fma_f32 v[100:101], v[100:101], v[100:101], v[108:109] op_sel:[1,1,0] op_sel_hi:[1,0,1] neg_lo:[1,0,0]
    v_pk_fma_f32 v[102:103], v[102:103], v[102:103], v[110:111] op_sel:[1,1,0] op_sel_hi:[1,0,1] neg_lo:[1,0,0]
    v_pk_mul_f32 v[104:105], v[154:155], v[96:97] op_sel:[0,0] op_sel_hi:[0,1]
    v_pk_mul_f32 v[106:107], v[158:159], v[98:99] op_sel:[0,0] op_sel_hi:[0,1]
    v_pk_mul_f32 v[108:109], v[162:163], v[100:101] op_sel:[0,0] op_sel_hi:[0,1]
    v_pk_mul_f32 v[110:111], v[166:167], v[102:103] op_sel:[0,0] op_sel_hi:[0,1]
    v_pk_fma_f32 v[112:113], v[154:155], v[96:97], v[104:105] op_sel:[1,1,0] op_sel_hi:[1,0,1] neg_lo:[1,0,0]
    v_pk_fma_f32 v[114:115], v[158:159], v[98:99], v[106:107] op_sel:[1,1,0] op_sel_hi:[1,0,1] neg_lo:[1,0,0]
    v_pk_fma_f32 v[116:117], v[162:163], v[100:101], v[108:109] op_sel:[1,1,0] op_sel_hi:[1,0,1] neg_lo:[1,0,0]
    v_pk_fma_f32 v[118:119], v[166:167], v[102:103], v[110:111] op_sel:[1,1,0] op_sel_hi:[1,0,1] neg_lo:[1,0,0]
    v_cvt_pk_bf16_f32 v144, v112, -v113
    v_cvt_pk_bf16_f32 v145, v114, -v115
    v_cvt_pk_bf16_f32 v146, v116, -v117
    v_cvt_pk_bf16_f32 v147, v118, -v119
    v_pk_mul_f32 v[104:105], v[96:97], v[96:97] op_sel:[0,0] op_sel_hi:[0,1]
    v_pk_mul_f32 v[106:107], v[98:99], v[98:99] op_sel:[0,0] op_sel_hi:[0,1]
    v_pk_mul_f32 v[108:109], v[100:101], v[100:101] op_sel:[0,0] op_sel_hi:[0,1]
    v_pk_mul_f32 v[110:111], v[102:103], v[102:103] op_sel:[0,0] op_sel_hi:[0,1]
    v_pk_fma_f32 v[96:97], v[96:97], v[96:97], v[104:105] op_sel:[1,1,0] op_sel_hi:[1,0,1] neg_lo:[1,0,0]
    v_pk_fma_f32 v[98:99], v[98:99], v[98:99], v[106:107] op_sel:[1,1,0] op_sel_hi:[1,0,1] neg_lo:[1,0,0]
    v_pk_fma_f32 v[100:101], v[100:101], v[100:101], v[108:109] op_sel:[1,1,0] op_sel_hi:[1,0,1] neg_lo:[1,0,0]
    v_pk_fma_f32 v[102:103], v[102:103], v[102:103], v[110:111] op_sel:[1,1,0] op_sel_hi:[1,0,1] neg_lo:[1,0,0]
    v_pk_mul_f32 v[104:105], v[154:155], v[96:97] op_sel:[0,0] op_sel_hi:[0,1]
    v_pk_mul_f32 v[106:107], v[158:159], v[98:99] op_sel:[0,0] op_sel_hi:[0,1]
    v_pk_mul_f32 v[108:109], v[162:163], v[100:101] op_sel:[0,0] op_sel_hi:[0,1]
    v_pk_mul_f32 v[110:111], v[166:167], v[102:103] op_sel:[0,0] op_sel_hi:[0,1]
    v_pk_fma_f32 v[112:113], v[154:155], v[96:97], v[104:105] op_sel:[1,1,0] op_sel_hi:[1,0,1] neg_lo:[1,0,0]
    v_pk_fma_f32 v[114:115], v[158:159], v[98:99], v[106:107] op_sel:[1,1,0] op_sel_hi:[1,0,1] neg_lo:[1,0,0]
    v_pk_fma_f32 v[116:117], v[162:163], v[100:101], v[108:109] op_sel:[1,1,0] op_sel_hi:[1,0,1] neg_lo:[1,0,0]
    v_pk_fma_f32 v[118:119], v[166:167], v[102:103], v[110:111] op_sel:[1,1,0] op_sel_hi:[1,0,1] neg_lo:[1,0,0]
    v_cvt_pk_bf16_f32 v148, v112, -v113
    v_cvt_pk_bf16_f32 v149, v114, -v115
    v_cvt_pk_bf16_f32 v150, v116, -v117
    v_cvt_pk_bf16_f32 v151, v118, -v119
    v_mfma_f32_16x16x32_bf16 v[64:67], v[136:139], v[120:123], v[64:67]
    v_mfma_f32_16x16x32_bf16 v[68:71], v[140:143], v[124:127], v[68:71]
    v_mfma_f32_16x16x32_bf16 v[72:75], v[144:147], v[128:131], v[72:75]
    v_mfma_f32_16x16x32_bf16 v[76:79], v[148:151], v[132:135], v[76:79]
    s_waitcnt lgkmcnt(0)
    ds_read_b128 v[152:155], v9 offset:768
    ds_read_b128 v[156:159], v9 offset:784
    ds_read_b128 v[160:163], v9 offset:800
    ds_read_b128 v[164:167], v9 offset:816
    v_mul_f32 v104, v80, v8
    v_mul_f32 v105, v81, v8
    v_mul_f32 v106, v84, v8
    v_mul_f32 v107, v85, v8
    v_mul_f32 v108, v88, v8
    v_mul_f32 v109, v89, v8
    v_mul_f32 v110, v92, v8
    v_mul_f32 v111, v93, v8
    v_exp_f32 v104, v104
    v_fract_f32 v105, v105
    v_exp_f32 v106, v106
    v_fract_f32 v107, v107
    v_exp_f32 v108, v108
    v_fract_f32 v109, v109
    v_exp_f32 v110, v110
    v_fract_f32 v111, v111
    v_cos_f32 v96, v105
    v_sin_f32 v97, v105
    v_cos_f32 v98, v107
    v_sin_f32 v99, v107
    v_cos_f32 v100, v109
    v_sin_f32 v101, v109
    v_cos_f32 v102, v111
    v_sin_f32 v103, v111
    v_pk_mul_f32 v[96:97], v[96:97], v[104:105] op_sel:[0,0] op_sel_hi:[1,0]
    v_pk_mul_f32 v[98:99], v[98:99], v[106:107] op_sel:[0,0] op_sel_hi:[1,0]
    v_pk_mul_f32 v[100:101], v[100:101], v[108:109] op_sel:[0,0] op_sel_hi:[1,0]
    v_pk_mul_f32 v[102:103], v[102:103], v[110:111] op_sel:[0,0] op_sel_hi:[1,0]
    v_cvt_pk_bf16_f32 v120, v96, v97
    v_cvt_pk_bf16_f32 v121, v98, v99
    v_cvt_pk_bf16_f32 v122, v100, v101
    v_cvt_pk_bf16_f32 v123, v102, v103
    v_pk_mul_f32 v[104:105], v[96:97], v[96:97] op_sel:[0,0] op_sel_hi:[0,1]
    v_pk_mul_f32 v[106:107], v[98:99], v[98:99] op_sel:[0,0] op_sel_hi:[0,1]
    v_pk_mul_f32 v[108:109], v[100:101], v[100:101] op_sel:[0,0] op_sel_hi:[0,1]
    v_pk_mul_f32 v[110:111], v[102:103], v[102:103] op_sel:[0,0] op_sel_hi:[0,1]
    v_pk_fma_f32 v[96:97], v[96:97], v[96:97], v[104:105] op_sel:[1,1,0] op_sel_hi:[1,0,1] neg_lo:[1,0,0]
    v_pk_fma_f32 v[98:99], v[98:99], v[98:99], v[106:107] op_sel:[1,1,0] op_sel_hi:[1,0,1] neg_lo:[1,0,0]
    v_pk_fma_f32 v[100:101], v[100:101], v[100:101], v[108:109] op_sel:[1,1,0] op_sel_hi:[1,0,1] neg_lo:[1,0,0]
    v_pk_fma_f32 v[102:103], v[102:103], v[102:103], v[110:111] op_sel:[1,1,0] op_sel_hi:[1,0,1] neg_lo:[1,0,0]
    v_cvt_pk_bf16_f32 v124, v96, v97
    v_cvt_pk_bf16_f32 v125, v98, v99
    v_cvt_pk_bf16_f32 v126, v100, v101
    v_cvt_pk_bf16_f32 v127, v102, v103
    v_pk_mul_f32 v[104:105], v[96:97], v[96:97] op_sel:[0,0] op_sel_hi:[0,1]
    v_pk_mul_f32 v[106:107], v[98:99], v[98:99] op_sel:[0,0] op_sel_hi:[0,1]
    v_pk_mul_f32 v[108:109], v[100:101], v[100:101] op_sel:[0,0] op_sel_hi:[0,1]
    v_pk_mul_f32 v[110:111], v[102:103], v[102:103] op_sel:[0,0] op_sel_hi:[0,1]
    v_pk_fma_f32 v[96:97], v[96:97], v[96:97], v[104:105] op_sel:[1,1,0] op_sel_hi:[1,0,1] neg_lo:[1,0,0]
    v_pk_fma_f32 v[98:99], v[98:99], v[98:99], v[106:107] op_sel:[1,1,0] op_sel_hi:[1,0,1] neg_lo:[1,0,0]
    v_pk_fma_f32 v[100:101], v[100:101], v[100:101], v[108:109] op_sel:[1,1,0] op_sel_hi:[1,0,1] neg_lo:[1,0,0]
    v_pk_fma_f32 v[102:103], v[102:103], v[102:103], v[110:111] op_sel:[1,1,0] op_sel_hi:[1,0,1] neg_lo:[1,0,0]
    v_cvt_pk_bf16_f32 v128, v96, v97
    v_cvt_pk_bf16_f32 v129, v98, v99
    v_cvt_pk_bf16_f32 v130, v100, v101
    v_cvt_pk_bf16_f32 v131, v102, v103
    v_pk_mul_f32 v[104:105], v[96:97], v[96:97] op_sel:[0,0] op_sel_hi:[0,1]
    v_pk_mul_f32 v[106:107], v[98:99], v[98:99] op_sel:[0,0] op_sel_hi:[0,1]
    v_pk_mul_f32 v[108:109], v[100:101], v[100:101] op_sel:[0,0] op_sel_hi:[0,1]
    v_pk_mul_f32 v[110:111], v[102:103], v[102:103] op_sel:[0,0] op_sel_hi:[0,1]
    v_pk_fma_f32 v[96:97], v[96:97], v[96:97], v[104:105] op_sel:[1,1,0] op_sel_hi:[1,0,1] neg_lo:[1,0,0]
    v_pk_fma_f32 v[98:99], v[98:99], v[98:99], v[106:107] op_sel:[1,1,0] op_sel_hi:[1,0,1] neg_lo:[1,0,0]
    v_pk_fma_f32 v[100:101], v[100:101], v[100:101], v[108:109] op_sel:[1,1,0] op_sel_hi:[1,0,1] neg_lo:[1,0,0]
    v_pk_fma_f32 v[102:103], v[102:103], v[102:103], v[110:111] op_sel:[1,1,0] op_sel_hi:[1,0,1] neg_lo:[1,0,0]
    v_cvt_pk_bf16_f32 v132, v96, v97
    v_cvt_pk_bf16_f32 v133, v98, v99
    v_cvt_pk_bf16_f32 v134, v100, v101
    v_cvt_pk_bf16_f32 v135, v102, v103
    v_pk_mul_f32 v[104:105], v[96:97], v[96:97] op_sel:[0,0] op_sel_hi:[0,1]
    v_pk_mul_f32 v[106:107], v[98:99], v[98:99] op_sel:[0,0] op_sel_hi:[0,1]
    v_pk_mul_f32 v[108:109], v[100:101], v[100:101] op_sel:[0,0] op_sel_hi:[0,1]
    v_pk_mul_f32 v[110:111], v[102:103], v[102:103] op_sel:[0,0] op_sel_hi:[0,1]
    v_pk_fma_f32 v[96:97], v[96:97], v[96:97], v[104:105] op_sel:[1,1,0] op_sel_hi:[1,0,1] neg_lo:[1,0,0]
    v_pk_fma_f32 v[98:99], v[98:99], v[98:99], v[106:107] op_sel:[1,1,0] op_sel_hi:[1,0,1] neg_lo:[1,0,0]
    v_pk_fma_f32 v[100:101], v[100:101], v[100:101], v[108:109] op_sel:[1,1,0] op_sel_hi:[1,0,1] neg_lo:[1,0,0]
    v_pk_fma_f32 v[102:103], v[102:103], v[102:103], v[110:111] op_sel:[1,1,0] op_sel_hi:[1,0,1] neg_lo:[1,0,0]
    v_pk_mul_f32 v[104:105], v[82:83], v[96:97] op_sel:[0,0] op_sel_hi:[0,1]
    v_pk_mul_f32 v[106:107], v[86:87], v[98:99] op_sel:[0,0] op_sel_hi:[0,1]
    v_pk_mul_f32 v[108:109], v[90:91], v[100:101] op_sel:[0,0] op_sel_hi:[0,1]
    v_pk_mul_f32 v[110:111], v[94:95], v[102:103] op_sel:[0,0] op_sel_hi:[0,1]
    v_pk_fma_f32 v[112:113], v[82:83], v[96:97], v[104:105] op_sel:[1,1,0] op_sel_hi:[1,0,1] neg_lo:[1,0,0]
    v_pk_fma_f32 v[114:115], v[86:87], v[98:99], v[106:107] op_sel:[1,1,0] op_sel_hi:[1,0,1] neg_lo:[1,0,0]
    v_pk_fma_f32 v[116:117], v[90:91], v[100:101], v[108:109] op_sel:[1,1,0] op_sel_hi:[1,0,1] neg_lo:[1,0,0]
    v_pk_fma_f32 v[118:119], v[94:95], v[102:103], v[110:111] op_sel:[1,1,0] op_sel_hi:[1,0,1] neg_lo:[1,0,0]
    v_cndmask_b32 v112, v112, v82, s[88:89]
    v_cndmask_b32 v113, v113, v83, s[88:89]
    v_cndmask_b32 v114, v114, v86, s[88:89]
    v_cndmask_b32 v115, v115, v87, s[88:89]
    v_cndmask_b32 v116, v116, v90, s[88:89]
    v_cndmask_b32 v117, v117, v91, s[88:89]
    v_cndmask_b32 v118, v118, v94, s[88:89]
    v_cndmask_b32 v119, v119, v95, s[88:89]
    v_cvt_pk_bf16_f32 v136, v112, -v113
    v_cvt_pk_bf16_f32 v137, v114, -v115
    v_cvt_pk_bf16_f32 v138, v116, -v117
    v_cvt_pk_bf16_f32 v139, v118, -v119
    v_pk_mul_f32 v[104:105], v[96:97], v[96:97] op_sel:[0,0] op_sel_hi:[0,1]
    v_pk_mul_f32 v[106:107], v[98:99], v[98:99] op_sel:[0,0] op_sel_hi:[0,1]
    v_pk_mul_f32 v[108:109], v[100:101], v[100:101] op_sel:[0,0] op_sel_hi:[0,1]
    v_pk_mul_f32 v[110:111], v[102:103], v[102:103] op_sel:[0,0] op_sel_hi:[0,1]
    v_pk_fma_f32 v[96:97], v[96:97], v[96:97], v[104:105] op_sel:[1,1,0] op_sel_hi:[1,0,1] neg_lo:[1,0,0]
    v_pk_fma_f32 v[98:99], v[98:99], v[98:99], v[106:107] op_sel:[1,1,0] op_sel_hi:[1,0,1] neg_lo:[1,0,0]
    v_pk_fma_f32 v[100:101], v[100:101], v[100:101], v[108:109] op_sel:[1,1,0] op_sel_hi:[1,0,1] neg_lo:[1,0,0]
    v_pk_fma_f32 v[102:103], v[102:103], v[102:103], v[110:111] op_sel:[1,1,0] op_sel_hi:[1,0,1] neg_lo:[1,0,0]
    v_pk_mul_f32 v[104:105], v[82:83], v[96:97] op_sel:[0,0] op_sel_hi:[0,1]
    v_pk_mul_f32 v[106:107], v[86:87], v[98:99] op_sel:[0,0] op_sel_hi:[0,1]
    v_pk_mul_f32 v[108:109], v[90:91], v[100:101] op_sel:[0,0] op_sel_hi:[0,1]
    v_pk_mul_f32 v[110:111], v[94:95], v[102:103] op_sel:[0,0] op_sel_hi:[0,1]
    v_pk_fma_f32 v[112:113], v[82:83], v[96:97], v[104:105] op_sel:[1,1,0] op_sel_hi:[1,0,1] neg_lo:[1,0,0]
    v_pk_fma_f32 v[114:115], v[86:87], v[98:99], v[106:107] op_sel:[1,1,0] op_sel_hi:[1,0,1] neg_lo:[1,0,0]
    v_pk_fma_f32 v[116:117], v[90:91], v[100:101], v[108:109] op_sel:[1,1,0] op_sel_hi:[1,0,1] neg_lo:[1,0,0]
    v_pk_fma_f32 v[118:119], v[94:95], v[102:103], v[110:111] op_sel:[1,1,0] op_sel_hi:[1,0,1] neg_lo:[1,0,0]
    v_cvt_pk_bf16_f32 v140, v112, -v113
    v_cvt_pk_bf16_f32 v141, v114, -v115
    v_cvt_pk_bf16_f32 v142, v116, -v117
    v_cvt_pk_bf16_f32 v143, v118, -v119
    v_pk_mul_f32 v[104:105], v[96:97], v[96:97] op_sel:[0,0] op_sel_hi:[0,1]
    v_pk_mul_f32 v[106:107], v[98:99], v[98:99] op_sel:[0,0] op_sel_hi:[0,1]
    v_pk_mul_f32 v[108:109], v[100:101], v[100:101] op_sel:[0,0] op_sel_hi:[0,1]
    v_pk_mul_f32 v[110:111], v[102:103], v[102:103] op_sel:[0,0] op_sel_hi:[0,1]
    v_pk_fma_f32 v[96:97], v[96:97], v[96:97], v[104:105] op_sel:[1,1,0] op_sel_hi:[1,0,1] neg_lo:[1,0,0]
    v_pk_fma_f32 v[98:99], v[98:99], v[98:99], v[106:107] op_sel:[1,1,0] op_sel_hi:[1,0,1] neg_lo:[1,0,0]
    v_pk_fma_f32 v[100:101], v[100:101], v[100:101], v[108:109] op_sel:[1,1,0] op_sel_hi:[1,0,1] neg_lo:[1,0,0]
    v_pk_fma_f32 v[102:103], v[102:103], v[102:103], v[110:111] op_sel:[1,1,0] op_sel_hi:[1,0,1] neg_lo:[1,0,0]
    v_pk_mul_f32 v[104:105], v[82:83], v[96:97] op_sel:[0,0] op_sel_hi:[0,1]
    v_pk_mul_f32 v[106:107], v[86:87], v[98:99] op_sel:[0,0] op_sel_hi:[0,1]
    v_pk_mul_f32 v[108:109], v[90:91], v[100:101] op_sel:[0,0] op_sel_hi:[0,1]
    v_pk_mul_f32 v[110:111], v[94:95], v[102:103] op_sel:[0,0] op_sel_hi:[0,1]
    v_pk_fma_f32 v[112:113], v[82:83], v[96:97], v[104:105] op_sel:[1,1,0] op_sel_hi:[1,0,1] neg_lo:[1,0,0]
    v_pk_fma_f32 v[114:115], v[86:87], v[98:99], v[106:107] op_sel:[1,1,0] op_sel_hi:[1,0,1] neg_lo:[1,0,0]
    v_pk_fma_f32 v[116:117], v[90:91], v[100:101], v[108:109] op_sel:[1,1,0] op_sel_hi:[1,0,1] neg_lo:[1,0,0]
    v_pk_fma_f32 v[118:119], v[94:95], v[102:103], v[110:111] op_sel:[1,1,0] op_sel_hi:[1,0,1] neg_lo:[1,0,0]
    v_cvt_pk_bf16_f32 v144, v112, -v113
    v_cvt_pk_bf16_f32 v145, v114, -v115
    v_cvt_pk_bf16_f32 v146, v116, -v117
    v_cvt_pk_bf16_f32 v147, v118, -v119
    v_pk_mul_f32 v[104:105], v[96:97], v[96:97] op_sel:[0,0] op_sel_hi:[0,1]
    v_pk_mul_f32 v[106:107], v[98:99], v[98:99] op_sel:[0,0] op_sel_hi:[0,1]
    v_pk_mul_f32 v[108:109], v[100:101], v[100:101] op_sel:[0,0] op_sel_hi:[0,1]
    v_pk_mul_f32 v[110:111], v[102:103], v[102:103] op_sel:[0,0] op_sel_hi:[0,1]
    v_pk_fma_f32 v[96:97], v[96:97], v[96:97], v[104:105] op_sel:[1,1,0] op_sel_hi:[1,0,1] neg_lo:[1,0,0]
    v_pk_fma_f32 v[98:99], v[98:99], v[98:99], v[106:107] op_sel:[1,1,0] op_sel_hi:[1,0,1] neg_lo:[1,0,0]
    v_pk_fma_f32 v[100:101], v[100:101], v[100:101], v[108:109] op_sel:[1,1,0] op_sel_hi:[1,0,1] neg_lo:[1,0,0]
    v_pk_fma_f32 v[102:103], v[102:103], v[102:103], v[110:111] op_sel:[1,1,0] op_sel_hi:[1,0,1] neg_lo:[1,0,0]
    v_pk_mul_f32 v[104:105], v[82:83], v[96:97] op_sel:[0,0] op_sel_hi:[0,1]
    v_pk_mul_f32 v[106:107], v[86:87], v[98:99] op_sel:[0,0] op_sel_hi:[0,1]
    v_pk_mul_f32 v[108:109], v[90:91], v[100:101] op_sel:[0,0] op_sel_hi:[0,1]
    v_pk_mul_f32 v[110:111], v[94:95], v[102:103] op_sel:[0,0] op_sel_hi:[0,1]
    v_pk_fma_f32 v[112:113], v[82:83], v[96:97], v[104:105] op_sel:[1,1,0] op_sel_hi:[1,0,1] neg_lo:[1,0,0]
    v_pk_fma_f32 v[114:115], v[86:87], v[98:99], v[106:107] op_sel:[1,1,0] op_sel_hi:[1,0,1] neg_lo:[1,0,0]
    v_pk_fma_f32 v[116:117], v[90:91], v[100:101], v[108:109] op_sel:[1,1,0] op_sel_hi:[1,0,1] neg_lo:[1,0,0]
    v_pk_fma_f32 v[118:119], v[94:95], v[102:103], v[110:111] op_sel:[1,1,0] op_sel_hi:[1,0,1] neg_lo:[1,0,0]
    v_cvt_pk_bf16_f32 v148, v112, -v113
    v_cvt_pk_bf16_f32 v149, v114, -v115
    v_cvt_pk_bf16_f32 v150, v116, -v117
    v_cvt_pk_bf16_f32 v151, v118, -v119
    v_mfma_f32_16x16x32_bf16 v[64:67], v[136:139], v[120:123], v[64:67]
    v_mfma_f32_16x16x32_bf16 v[68:71], v[140:143], v[124:127], v[68:71]
    v_mfma_f32_16x16x32_bf16 v[72:75], v[144:147], v[128:131], v[72:75]
    v_mfma_f32_16x16x32_bf16 v[76:79], v[148:151], v[132:135], v[76:79]
    s_waitcnt lgkmcnt(0)
    v_mul_f32 v104, v152, v8
    v_mul_f32 v105, v153, v8
    v_mul_f32 v106, v156, v8
    v_mul_f32 v107, v157, v8
    v_mul_f32 v108, v160, v8
    v_mul_f32 v109, v161, v8
    v_mul_f32 v110, v164, v8
    v_mul_f32 v111, v165, v8
    v_exp_f32 v104, v104
    v_fract_f32 v105, v105
    v_exp_f32 v106, v106
    v_fract_f32 v107, v107
    v_exp_f32 v108, v108
    v_fract_f32 v109, v109
    v_exp_f32 v110, v110
    v_fract_f32 v111, v111
    v_cos_f32 v96, v105
    v_sin_f32 v97, v105
    v_cos_f32 v98, v107
    v_sin_f32 v99, v107
    v_cos_f32 v100, v109
    v_sin_f32 v101, v109
    v_cos_f32 v102, v111
    v_sin_f32 v103, v111
    v_pk_mul_f32 v[96:97], v[96:97], v[104:105] op_sel:[0,0] op_sel_hi:[1,0]
    v_pk_mul_f32 v[98:99], v[98:99], v[106:107] op_sel:[0,0] op_sel_hi:[1,0]
    v_pk_mul_f32 v[100:101], v[100:101], v[108:109] op_sel:[0,0] op_sel_hi:[1,0]
    v_pk_mul_f32 v[102:103], v[102:103], v[110:111] op_sel:[0,0] op_sel_hi:[1,0]
    v_cvt_pk_bf16_f32 v120, v96, v97
    v_cvt_pk_bf16_f32 v121, v98, v99
    v_cvt_pk_bf16_f32 v122, v100, v101
    v_cvt_pk_bf16_f32 v123, v102, v103
    v_pk_mul_f32 v[104:105], v[96:97], v[96:97] op_sel:[0,0] op_sel_hi:[0,1]
    v_pk_mul_f32 v[106:107], v[98:99], v[98:99] op_sel:[0,0] op_sel_hi:[0,1]
    v_pk_mul_f32 v[108:109], v[100:101], v[100:101] op_sel:[0,0] op_sel_hi:[0,1]
    v_pk_mul_f32 v[110:111], v[102:103], v[102:103] op_sel:[0,0] op_sel_hi:[0,1]
    v_pk_fma_f32 v[96:97], v[96:97], v[96:97], v[104:105] op_sel:[1,1,0] op_sel_hi:[1,0,1] neg_lo:[1,0,0]
    v_pk_fma_f32 v[98:99], v[98:99], v[98:99], v[106:107] op_sel:[1,1,0] op_sel_hi:[1,0,1] neg_lo:[1,0,0]
    v_pk_fma_f32 v[100:101], v[100:101], v[100:101], v[108:109] op_sel:[1,1,0] op_sel_hi:[1,0,1] neg_lo:[1,0,0]
    v_pk_fma_f32 v[102:103], v[102:103], v[102:103], v[110:111] op_sel:[1,1,0] op_sel_hi:[1,0,1] neg_lo:[1,0,0]
    v_cvt_pk_bf16_f32 v124, v96, v97
    v_cvt_pk_bf16_f32 v125, v98, v99
    v_cvt_pk_bf16_f32 v126, v100, v101
    v_cvt_pk_bf16_f32 v127, v102, v103
    v_pk_mul_f32 v[104:105], v[96:97], v[96:97] op_sel:[0,0] op_sel_hi:[0,1]
    v_pk_mul_f32 v[106:107], v[98:99], v[98:99] op_sel:[0,0] op_sel_hi:[0,1]
    v_pk_mul_f32 v[108:109], v[100:101], v[100:101] op_sel:[0,0] op_sel_hi:[0,1]
    v_pk_mul_f32 v[110:111], v[102:103], v[102:103] op_sel:[0,0] op_sel_hi:[0,1]
    v_pk_fma_f32 v[96:97], v[96:97], v[96:97], v[104:105] op_sel:[1,1,0] op_sel_hi:[1,0,1] neg_lo:[1,0,0]
    v_pk_fma_f32 v[98:99], v[98:99], v[98:99], v[106:107] op_sel:[1,1,0] op_sel_hi:[1,0,1] neg_lo:[1,0,0]
    v_pk_fma_f32 v[100:101], v[100:101], v[100:101], v[108:109] op_sel:[1,1,0] op_sel_hi:[1,0,1] neg_lo:[1,0,0]
    v_pk_fma_f32 v[102:103], v[102:103], v[102:103], v[110:111] op_sel:[1,1,0] op_sel_hi:[1,0,1] neg_lo:[1,0,0]
    v_cvt_pk_bf16_f32 v128, v96, v97
    v_cvt_pk_bf16_f32 v129, v98, v99
    v_cvt_pk_bf16_f32 v130, v100, v101
    v_cvt_pk_bf16_f32 v131, v102, v103
    v_pk_mul_f32 v[104:105], v[96:97], v[96:97] op_sel:[0,0] op_sel_hi:[0,1]
    v_pk_mul_f32 v[106:107], v[98:99], v[98:99] op_sel:[0,0] op_sel_hi:[0,1]
    v_pk_mul_f32 v[108:109], v[100:101], v[100:101] op_sel:[0,0] op_sel_hi:[0,1]
    v_pk_mul_f32 v[110:111], v[102:103], v[102:103] op_sel:[0,0] op_sel_hi:[0,1]
    v_pk_fma_f32 v[96:97], v[96:97], v[96:97], v[104:105] op_sel:[1,1,0] op_sel_hi:[1,0,1] neg_lo:[1,0,0]
    v_pk_fma_f32 v[98:99], v[98:99], v[98:99], v[106:107] op_sel:[1,1,0] op_sel_hi:[1,0,1] neg_lo:[1,0,0]
    v_pk_fma_f32 v[100:101], v[100:101], v[100:101], v[108:109] op_sel:[1,1,0] op_sel_hi:[1,0,1] neg_lo:[1,0,0]
    v_pk_fma_f32 v[102:103], v[102:103], v[102:103], v[110:111] op_sel:[1,1,0] op_sel_hi:[1,0,1] neg_lo:[1,0,0]
    v_cvt_pk_bf16_f32 v132, v96, v97
    v_cvt_pk_bf16_f32 v133, v98, v99
    v_cvt_pk_bf16_f32 v134, v100, v101
    v_cvt_pk_bf16_f32 v135, v102, v103
    v_pk_mul_f32 v[104:105], v[96:97], v[96:97] op_sel:[0,0] op_sel_hi:[0,1]
    v_pk_mul_f32 v[106:107], v[98:99], v[98:99] op_sel:[0,0] op_sel_hi:[0,1]
    v_pk_mul_f32 v[108:109], v[100:101], v[100:101] op_sel:[0,0] op_sel_hi:[0,1]
    v_pk_mul_f32 v[110:111], v[102:103], v[102:103] op_sel:[0,0] op_sel_hi:[0,1]
    v_pk_fma_f32 v[96:97], v[96:97], v[96:97], v[104:105] op_sel:[1,1,0] op_sel_hi:[1,0,1] neg_lo:[1,0,0]
    v_pk_fma_f32 v[98:99], v[98:99], v[98:99], v[106:107] op_sel:[1,1,0] op_sel_hi:[1,0,1] neg_lo:[1,0,0]
    v_pk_fma_f32 v[100:101], v[100:101], v[100:101], v[108:109] op_sel:[1,1,0] op_sel_hi:[1,0,1] neg_lo:[1,0,0]
    v_pk_fma_f32 v[102:103], v[102:103], v[102:103], v[110:111] op_sel:[1,1,0] op_sel_hi:[1,0,1] neg_lo:[1,0,0]
    v_pk_mul_f32 v[104:105], v[154:155], v[96:97] op_sel:[0,0] op_sel_hi:[0,1]
    v_pk_mul_f32 v[106:107], v[158:159], v[98:99] op_sel:[0,0] op_sel_hi:[0,1]
    v_pk_mul_f32 v[108:109], v[162:163], v[100:101] op_sel:[0,0] op_sel_hi:[0,1]
    v_pk_mul_f32 v[110:111], v[166:167], v[102:103] op_sel:[0,0] op_sel_hi:[0,1]
    v_pk_fma_f32 v[112:113], v[154:155], v[96:97], v[104:105] op_sel:[1,1,0] op_sel_hi:[1,0,1] neg_lo:[1,0,0]
    v_pk_fma_f32 v[114:115], v[158:159], v[98:99], v[106:107] op_sel:[1,1,0] op_sel_hi:[1,0,1] neg_lo:[1,0,0]
    v_pk_fma_f32 v[116:117], v[162:163], v[100:101], v[108:109] op_sel:[1,1,0] op_sel_hi:[1,0,1] neg_lo:[1,0,0]
    v_pk_fma_f32 v[118:119], v[166:167], v[102:103], v[110:111] op_sel:[1,1,0] op_sel_hi:[1,0,1] neg_lo:[1,0,0]
    v_cndmask_b32 v112, v112, v154, s[88:89]
    v_cndmask_b32 v113, v113, v155, s[88:89]
    v_cndmask_b32 v114, v114, v158, s[88:89]
    v_cndmask_b32 v115, v115, v159, s[88:89]
    v_cndmask_b32 v116, v116, v162, s[88:89]
    v_cndmask_b32 v117, v117, v163, s[88:89]
    v_cndmask_b32 v118, v118, v166, s[88:89]
    v_cndmask_b32 v119, v119, v167, s[88:89]
    v_cvt_pk_bf16_f32 v136, v112, -v113
    v_cvt_pk_bf16_f32 v137, v114, -v115
    v_cvt_pk_bf16_f32 v138, v116, -v117
    v_cvt_pk_bf16_f32 v139, v118, -v119
    v_pk_mul_f32 v[104:105], v[96:97], v[96:97] op_sel:[0,0] op_sel_hi:[0,1]
    v_pk_mul_f32 v[106:107], v[98:99], v[98:99] op_sel:[0,0] op_sel_hi:[0,1]
    v_pk_mul_f32 v[108:109], v[100:101], v[100:101] op_sel:[0,0] op_sel_hi:[0,1]
    v_pk_mul_f32 v[110:111], v[102:103], v[102:103] op_sel:[0,0] op_sel_hi:[0,1]
    v_pk_fma_f32 v[96:97], v[96:97], v[96:97], v[104:105] op_sel:[1,1,0] op_sel_hi:[1,0,1] neg_lo:[1,0,0]
    v_pk_fma_f32 v[98:99], v[98:99], v[98:99], v[106:107] op_sel:[1,1,0] op_sel_hi:[1,0,1] neg_lo:[1,0,0]
    v_pk_fma_f32 v[100:101], v[100:101], v[100:101], v[108:109] op_sel:[1,1,0] op_sel_hi:[1,0,1] neg_lo:[1,0,0]
    v_pk_fma_f32 v[102:103], v[102:103], v[102:103], v[110:111] op_sel:[1,1,0] op_sel_hi:[1,0,1] neg_lo:[1,0,0]
    v_pk_mul_f32 v[104:105], v[154:155], v[96:97] op_sel:[0,0] op_sel_hi:[0,1]
    v_pk_mul_f32 v[106:107], v[158:159], v[98:99] op_sel:[0,0] op_sel_hi:[0,1]
    v_pk_mul_f32 v[108:109], v[162:163], v[100:101] op_sel:[0,0] op_sel_hi:[0,1]
    v_pk_mul_f32 v[110:111], v[166:167], v[102:103] op_sel:[0,0] op_sel_hi:[0,1]
    v_pk_fma_f32 v[112:113], v[154:155], v[96:97], v[104:105] op_sel:[1,1,0] op_sel_hi:[1,0,1] neg_lo:[1,0,0]
    v_pk_fma_f32 v[114:115], v[158:159], v[98:99], v[106:107] op_sel:[1,1,0] op_sel_hi:[1,0,1] neg_lo:[1,0,0]
    v_pk_fma_f32 v[116:117], v[162:163], v[100:101], v[108:109] op_sel:[1,1,0] op_sel_hi:[1,0,1] neg_lo:[1,0,0]
    v_pk_fma_f32 v[118:119], v[166:167], v[102:103], v[110:111] op_sel:[1,1,0] op_sel_hi:[1,0,1] neg_lo:[1,0,0]
    v_cvt_pk_bf16_f32 v140, v112, -v113
    v_cvt_pk_bf16_f32 v141, v114, -v115
    v_cvt_pk_bf16_f32 v142, v116, -v117
    v_cvt_pk_bf16_f32 v143, v118, -v119
    v_pk_mul_f32 v[104:105], v[96:97], v[96:97] op_sel:[0,0] op_sel_hi:[0,1]
    v_pk_mul_f32 v[106:107], v[98:99], v[98:99] op_sel:[0,0] op_sel_hi:[0,1]
    v_pk_mul_f32 v[108:109], v[100:101], v[100:101] op_sel:[0,0] op_sel_hi:[0,1]
    v_pk_mul_f32 v[110:111], v[102:103], v[102:103] op_sel:[0,0] op_sel_hi:[0,1]
    v_pk_fma_f32 v[96:97], v[96:97], v[96:97], v[104:105] op_sel:[1,1,0] op_sel_hi:[1,0,1] neg_lo:[1,0,0]
    v_pk_fma_f32 v[98:99], v[98:99], v[98:99], v[106:107] op_sel:[1,1,0] op_sel_hi:[1,0,1] neg_lo:[1,0,0]
    v_pk_fma_f32 v[100:101], v[100:101], v[100:101], v[108:109] op_sel:[1,1,0] op_sel_hi:[1,0,1] neg_lo:[1,0,0]
    v_pk_fma_f32 v[102:103], v[102:103], v[102:103], v[110:111] op_sel:[1,1,0] op_sel_hi:[1,0,1] neg_lo:[1,0,0]
    v_pk_mul_f32 v[104:105], v[154:155], v[96:97] op_sel:[0,0] op_sel_hi:[0,1]
    v_pk_mul_f32 v[106:107], v[158:159], v[98:99] op_sel:[0,0] op_sel_hi:[0,1]
    v_pk_mul_f32 v[108:109], v[162:163], v[100:101] op_sel:[0,0] op_sel_hi:[0,1]
    v_pk_mul_f32 v[110:111], v[166:167], v[102:103] op_sel:[0,0] op_sel_hi:[0,1]
    v_pk_fma_f32 v[112:113], v[154:155], v[96:97], v[104:105] op_sel:[1,1,0] op_sel_hi:[1,0,1] neg_lo:[1,0,0]
    v_pk_fma_f32 v[114:115], v[158:159], v[98:99], v[106:107] op_sel:[1,1,0] op_sel_hi:[1,0,1] neg_lo:[1,0,0]
    v_pk_fma_f32 v[116:117], v[162:163], v[100:101], v[108:109] op_sel:[1,1,0] op_sel_hi:[1,0,1] neg_lo:[1,0,0]
    v_pk_fma_f32 v[118:119], v[166:167], v[102:103], v[110:111] op_sel:[1,1,0] op_sel_hi:[1,0,1] neg_lo:[1,0,0]
    v_cvt_pk_bf16_f32 v144, v112, -v113
    v_cvt_pk_bf16_f32 v145, v114, -v115
    v_cvt_pk_bf16_f32 v146, v116, -v117
    v_cvt_pk_bf16_f32 v147, v118, -v119
    v_pk_mul_f32 v[104:105], v[96:97], v[96:97] op_sel:[0,0] op_sel_hi:[0,1]
    v_pk_mul_f32 v[106:107], v[98:99], v[98:99] op_sel:[0,0] op_sel_hi:[0,1]
    v_pk_mul_f32 v[108:109], v[100:101], v[100:101] op_sel:[0,0] op_sel_hi:[0,1]
    v_pk_mul_f32 v[110:111], v[102:103], v[102:103] op_sel:[0,0] op_sel_hi:[0,1]
    v_pk_fma_f32 v[96:97], v[96:97], v[96:97], v[104:105] op_sel:[1,1,0] op_sel_hi:[1,0,1] neg_lo:[1,0,0]
    v_pk_fma_f32 v[98:99], v[98:99], v[98:99], v[106:107] op_sel:[1,1,0] op_sel_hi:[1,0,1] neg_lo:[1,0,0]
    v_pk_fma_f32 v[100:101], v[100:101], v[100:101], v[108:109] op_sel:[1,1,0] op_sel_hi:[1,0,1] neg_lo:[1,0,0]
    v_pk_fma_f32 v[102:103], v[102:103], v[102:103], v[110:111] op_sel:[1,1,0] op_sel_hi:[1,0,1] neg_lo:[1,0,0]
    v_pk_mul_f32 v[104:105], v[154:155], v[96:97] op_sel:[0,0] op_sel_hi:[0,1]
    v_pk_mul_f32 v[106:107], v[158:159], v[98:99] op_sel:[0,0] op_sel_hi:[0,1]
    v_pk_mul_f32 v[108:109], v[162:163], v[100:101] op_sel:[0,0] op_sel_hi:[0,1]
    v_pk_mul_f32 v[110:111], v[166:167], v[102:103] op_sel:[0,0] op_sel_hi:[0,1]
    v_pk_fma_f32 v[112:113], v[154:155], v[96:97], v[104:105] op_sel:[1,1,0] op_sel_hi:[1,0,1] neg_lo:[1,0,0]
    v_pk_fma_f32 v[114:115], v[158:159], v[98:99], v[106:107] op_sel:[1,1,0] op_sel_hi:[1,0,1] neg_lo:[1,0,0]
    v_pk_fma_f32 v[116:117], v[162:163], v[100:101], v[108:109] op_sel:[1,1,0] op_sel_hi:[1,0,1] neg_lo:[1,0,0]
    v_pk_fma_f32 v[118:119], v[166:167], v[102:103], v[110:111] op_sel:[1,1,0] op_sel_hi:[1,0,1] neg_lo:[1,0,0]
    v_cvt_pk_bf16_f32 v148, v112, -v113
    v_cvt_pk_bf16_f32 v149, v114, -v115
    v_cvt_pk_bf16_f32 v150, v116, -v117
    v_cvt_pk_bf16_f32 v151, v118, -v119
    v_mfma_f32_16x16x32_bf16 v[64:67], v[136:139], v[120:123], v[64:67]
    v_mfma_f32_16x16x32_bf16 v[68:71], v[140:143], v[124:127], v[68:71]
    v_mfma_f32_16x16x32_bf16 v[72:75], v[144:147], v[128:131], v[72:75]
    v_mfma_f32_16x16x32_bf16 v[76:79], v[148:151], v[132:135], v[76:79]
    s_lshl_b32 s60, s38, 12
    s_add_u32 s60, s60, 20480
    v_add_u32 v10, s60, v6
    s_cmp_eq_u32 s39, 0
    s_cbranch_scc1 L_prep_h0a
    ds_write_b128 v10, v[64:67] offset:0
    ds_write_b128 v10, v[68:71] offset:1024
    ds_write_b128 v10, v[72:75] offset:2048
    ds_write_b128 v10, v[76:79] offset:3072
L_prep_h0a:
    s_waitcnt vmcnt(0)
    v_mov_b32 v16, 0
    v_mov_b32 v17, 0
    v_dot2_f32_bf16 v16, v20, v28, v16
    v_dot2_f32_bf16 v17, v24, v28, v17
    v_dot2_f32_bf16 v16, v21, v29, v16
    v_dot2_f32_bf16 v17, v25, v29, v17
    v_dot2_f32_bf16 v16, v22, v30, v16
    v_dot2_f32_bf16 v17, v26, v30, v17
    v_dot2_f32_bf16 v16, v23, v31, v16
    v_dot2_f32_bf16 v17, v27, v31, v17
    s_nop 1
    v_add_f32 v16, v16, v16 row_shr:1 row_mask:0xf bank_mask:0xf bound_ctrl:0
    v_add_f32 v17, v17, v17 row_shr:1 row_mask:0xf bank_mask:0xf bound_ctrl:0
    s_nop 0
    v_add_f32 v16, v16, v16 row_shr:2 row_mask:0xf bank_mask:0xf bound_ctrl:0
    v_add_f32 v17, v17, v17 row_shr:2 row_mask:0xf bank_mask:0xf bound_ctrl:0
    s_nop 0
    v_add_f32 v16, v16, v16 row_shr:4 row_mask:0xf bank_mask:0xf bound_ctrl:0
    v_add_f32 v17, v17, v17 row_shr:4 row_mask:0xf bank_mask:0xf bound_ctrl:0
    s_nop 0
    v_add_f32 v16, v16, v16 row_shr:8 row_mask:0xf bank_mask:0xf bound_ctrl:0
    v_add_f32 v17, v17, v17 row_shr:8 row_mask:0xf bank_mask:0xf bound_ctrl:0
    s_nop 0
    v_add_f32 v16, v16, v16 row_bcast:15 row_mask:0xa bank_mask:0xf
    v_add_f32 v17, v17, v17 row_bcast:15 row_mask:0xa bank_mask:0xf
    s_nop 0
    v_add_f32 v16, v16, v16 row_bcast:31 row_mask:0xc bank_mask:0xf
    v_add_f32 v17, v17, v17 row_bcast:31 row_mask:0xc bank_mask:0xf
    v_cvt_pk_bf16_f32 v16, v16, v16
    v_cvt_pk_bf16_f32 v17, v17, v17
    v_lshlrev_b32 v16, 16, v16
    v_lshlrev_b32 v17, 16, v17
    v_mul_f32 v16, 0xbfb8aa3b, v16
    v_mul_f32 v17, 0xbfb8aa3b, v17
    v_exp_f32 v16, v16
    v_exp_f32 v17, v17
    v_add_f32 v16, 1.0, v16
    v_add_f32 v17, 1.0, v17
    v_rcp_f32 v16, v16
    v_rcp_f32 v17, v17
    v_cvt_pk_bf16_f32 v16, v16, v16
    v_cvt_pk_bf16_f32 v17, v17, v17
    v_lshlrev_b32 v12, 16, v16
    v_lshlrev_b32 v14, 16, v17
    v_sub_f32 v13, 1.0, v12
    v_sub_f32 v15, 1.0, v14
    v_cvt_pk_bf16_f32 v13, v13, v13
    v_cvt_pk_bf16_f32 v15, v15, v15
    v_lshlrev_b32 v13, 16, v13
    v_lshlrev_b32 v15, 16, v15
    s_lshl_b32 s79, s78, 3
    v_mov_b32 v9, 0
    v_cmp_eq_u32 vcc, 63, v1
    s_nop 0
    s_and_saveexec_b64 s[90:91], vcc
    buffer_store_dwordx4 v[12:15], v9, s[56:59], s79 offen sc1
    s_mov_b64 exec, s[90:91]
    s_cmp_ge_u32 s72, 896
    s_cbranch_scc1 L_prep_now2b
    v_lshrrev_b32 v12, 2, v1
    v_lshlrev_b32 v12, 6, v12
    v_and_b32 v13, 3, v1
    v_lshl_add_u32 v12, v13, 4, v12
    s_lshl_b32 s63, s37, 11
    s_add_u32 s63, s63, 8192
    v_add_u32 v12, s63, v12
    ds_read_b64_tr_b16 v[20:21], v12
    ds_read_b64_tr_b16 v[22:23], v12 offset:1024
    ds_read_b64_tr_b16 v[24:25], v12 offset:8
    ds_read_b64_tr_b16 v[26:27], v12 offset:1032
    s_mul_i32 s76, s74, 56
    s_add_u32 s76, s76, s73
    s_lshl_b32 s76, s76, 2
    s_lshl_b32 s77, s75, 1
    s_add_u32 s76, s76, s77
    s_lshl_b32 s76, s76, 10
    s_waitcnt lgkmcnt(0)
    buffer_store_dwordx4 v[20:23], v6, s[52:55], s76 offen sc1
    buffer_store_dwordx4 v[24:27], v6, s[52:55], s76 offen offset:1024 sc1
L_prep_now2b:
    v_lshrrev_b32 v32, 4, v1
    v_lshlrev_b32 v32, 3, v32
    v_bfe_u32 v33, v1, 2, 2
    v_add_u32 v32, v32, v33
    v_lshlrev_b32 v32, 7, v32
    v_and_b32 v33, 3, v1
    v_lshl_add_u32 v32, v33, 3, v32
    s_lshl_b32 s63, s37, 5
    s_add_u32 s63, s63, 0
    v_add_u32 v32, s63, v32
    s_waitcnt lgkmcnt(0)
    s_barrier
    ds_read_b64_tr_b16 v[36:37], v32
    ds_read_b64_tr_b16 v[38:39], v32 offset:512
    ds_read_b64_tr_b16 v[40:41], v32 offset:4096
    ds_read_b64_tr_b16 v[42:43], v32 offset:4608
    s_cmp_eq_u32 s39, 0
    s_cbranch_scc0 L_prep_h1b
    ds_read_b128 v[80:83], v10 offset:0
    ds_read_b128 v[84:87], v10 offset:1024
    ds_read_b128 v[88:91], v10 offset:2048
    ds_read_b128 v[92:95], v10 offset:3072
    s_lshl_b32 s61, s38, 3
    s_add_u32 s61, s61, 33024
    v_mov_b32 v11, s61
    ds_read_b64 v[12:13], v11
    v_lshrrev_b32 v14, 4, v1
    v_lshlrev_b32 v14, 2, v14
    v_and_b32 v15, 15, v1
    v_lshlrev_b32 v15, 1, v15
    v_add_u32 v15, s80, v15
    v_add_u32 v16, 1, v14
    v_and_b32 v16, 15, v16
    v_lshl_add_u32 v16, v16, 5, v15
    v_add_u32 v17, 2, v14
    v_and_b32 v17, 15, v17
    v_lshl_add_u32 v17, v17, 5, v15
    v_add_u32 v18, 3, v14
    v_and_b32 v18, 15, v18
    v_lshl_add_u32 v18, v18, 5, v15
    v_add_u32 v19, 4, v14
    v_and_b32 v19, 15, v19
    v_lshl_add_u32 v19, v19, 5, v15
    s_waitcnt lgkmcnt(0)
    v_add_f32 v64, v64, v80
    v_add_f32 v65, v65, v81
    v_add_f32 v66, v66, v82
    v_add_f32 v67, v67, v83
    v_cvt_pk_bf16_f32 v104, v64, v65
    v_cvt_pk_bf16_f32 v105, v66, v67
    ds_write_b16 v16, v104 offset:0
    ds_write_b16_d16_hi v17, v104 offset:0
    ds_write_b16 v18, v105 offset:0
    ds_write_b16_d16_hi v19, v105 offset:0
    v_add_f32 v68, v68, v84
    v_add_f32 v69, v69, v85
    v_add_f32 v70, v70, v86
    v_add_f32 v71, v71, v87
    v_cvt_pk_bf16_f32 v106, v68, v69
    v_cvt_pk_bf16_f32 v107, v70, v71
    ds_write_b16 v16, v106 offset:512
    ds_write_b16_d16_hi v17, v106 offset:512
    ds_write_b16 v18, v107 offset:512
    ds_write_b16_d16_hi v19, v107 offset:512
    v_add_f32 v72, v72, v88
    v_add_f32 v73, v73, v89
    v_add_f32 v74, v74, v90
    v_add_f32 v75, v75, v91
    v_cvt_pk_bf16_f32 v108, v72, v73
    v_cvt_pk_bf16_f32 v109, v74, v75
    ds_write_b16 v16, v108 offset:1024
    ds_write_b16_d16_hi v17, v108 offset:1024
    ds_write_b16 v18, v109 offset:1024
    ds_write_b16_d16_hi v19, v109 offset:1024
    v_add_f32 v76, v76, v92
    v_add_f32 v77, v77, v93
    v_add_f32 v78, v78, v94
    v_add_f32 v79, v79, v95
    v_cvt_pk_bf16_f32 v110, v76, v77
    v_cvt_pk_bf16_f32 v111, v78, v79
    ds_write_b16 v16, v110 offset:1536
    ds_write_b16_d16_hi v17, v110 offset:1536
    ds_write_b16 v18, v111 offset:1536
    ds_write_b16_d16_hi v19, v111 offset:1536
    v_add_f32 v12, v12, v13
    v_cvt_pk_bf16_f32 v12, v12, v12
    v_lshlrev_b32 v12, 16, v12
    s_sub_u32 s61, s80, 4
    v_mov_b32 v11, s61
    ds_write_b32 v11, v12
L_prep_h1b:
    s_lshl_b32 s61, s95, 18
    s_lshl_b32 s62, s37, 16
    s_add_u32 s61, s61, s62
    s_lshl_b32 s60, s94, 7
    s_add_u32 s61, s61, s60
    v_and_b32 v13, 15, v1
    v_lshlrev_b32 v13, 12, v13
    v_lshrrev_b32 v14, 4, v1
    v_lshl_add_u32 v13, v14, 4, v13
    s_waitcnt lgkmcnt(0)
    buffer_store_dwordx4 v[36:39], v13, s[48:51], s61 offen sc1
    buffer_store_dwordx4 v[40:43], v13, s[48:51], s61 offen offset:64 sc1
    s_mul_i32 s60, s42, 8320
    s_lshl_b32 s61, s39, 11
    s_sub_u32 s62, s60, s61
    s_add_u32 s62, s62, 3056
    v_sub_u32 v12, 0, v6
    v_add_u32 v12, s62, v12
    s_movk_i32 s63, 4160
    s_barrier
    s_cmp_eq_u32 s39, 0
    s_cbranch_scc1 L_prep_e0
    s_add_u32 s60, s80, 1790
    v_lshl_add_u32 v14, v1, 1, s60
    v_and_b32 v15, 1, v1
    v_lshl_add_u32 v15, v15, 1, v14
    ds_read_u16 v80, v14 offset:0
    ds_read_u16 v81, v14 offset:2
    ds_read_u16 v82, v15 offset:0
    ds_read_u16 v83, v14 offset:128
    ds_read_u16 v84, v14 offset:130
    ds_read_u16 v85, v15 offset:128
    v_mov_b32 v104, 0
    v_mov_b32 v105, 0
    v_mov_b32 v106, 0
    v_mov_b32 v107, 0
    s_lshl_b32 s61, s95, 5
    s_lshr_b32 s60, s36, 6
    s_lshl_b32 s60, s60, 3
    s_add_u32 s61, s61, s60
    s_add_u32 s61, s61, s92
    s_lshl_b32 s61, s61, 7
    s_waitcnt lgkmcnt(0)
    v_lshl_or_b32 v88, v81, 16, v81
    v_lshl_or_b32 v89, v82, 16, v81
    v_lshl_or_b32 v90, v80, 16, v80
    v_lshl_or_b32 v91, v80, 16, v80
    v_lshl_or_b32 v92, v81, 16, v81
    v_lshl_or_b32 v93, v80, 16, v82
    v_lshl_or_b32 v94, v80, 16, v80
    v_lshl_or_b32 v95, v80, 16, v80
    buffer_store_dwordx4 v[88:91], v12, s[44:47], 0 offen offset:1024 sc1
    buffer_store_dwordx4 v[92:95], v12, s[44:47], s63 offen offset:1024 sc1
    v_lshl_or_b32 v96, v84, 16, v84
    v_lshl_or_b32 v97, v85, 16, v84
    v_lshl_or_b32 v98, v83, 16, v83
    v_lshl_or_b32 v99, v83, 16, v83
    v_lshl_or_b32 v100, v84, 16, v84
    v_lshl_or_b32 v101, v83, 16, v85
    v_lshl_or_b32 v102, v83, 16, v83
    v_lshl_or_b32 v103, v83, 16, v83
    buffer_store_dwordx4 v[96:99], v12, s[44:47], 0 offen offset:0 sc1
    buffer_store_dwordx4 v[100:103], v12, s[44:47], s63 offen offset:0 sc1
    s_cmp_eq_u32 s38, 0
    s_cbranch_scc0 L_prep_end
    s_mov_b64 exec, 0xff
    buffer_store_dwordx4 v[104:107], v6, s[84:87], s61 offen sc1
    s_branch L_prep_end
L_prep_e0:
    s_add_u32 s60, s80, 1278
    v_lshl_add_u32 v14, v1, 2, s60
    ds_read_u16 v80, v14 offset:0
    ds_read_u16 v81, v14 offset:2
    ds_read_u16 v82, v14 offset:4
    s_sub_u32 s60, s80, 4
    v_lshl_add_u32 v15, v1, 4, s60
    s_add_u32 s60, s80, 510
    v_lshl_add_u32 v16, v1, 3, s60
    s_add_u32 s60, s80, 508
    v_mov_b32 v17, s60
    s_mov_b64 exec, 0xffffffff
    ds_read_u16 v108, v15 offset:0
    ds_read_u16 v109, v15 offset:2
    ds_read_u16 v110, v15 offset:4
    ds_read_u16 v111, v15 offset:6
    ds_read_u16 v112, v15 offset:8
    ds_read_u16 v113, v15 offset:10
    ds_read_u16 v114, v15 offset:12
    ds_read_u16 v115, v15 offset:14
    ds_read_u16 v116, v15 offset:16
    s_mov_b32 exec_lo, 0
    s_mov_b32 exec_hi, -1
    ds_read_u16 v109, v16 offset:0
    ds_read_u16 v110, v16 offset:0
    ds_read_u16 v111, v16 offset:2
    ds_read_u16 v112, v16 offset:4
    ds_read_u16 v113, v16 offset:4
    ds_read_u16 v114, v16 offset:4
    ds_read_u16 v115, v16 offset:6
    ds_read_u16 v116, v16 offset:8
    s_mov_b32 exec_hi, 0xfffffffe
    ds_read_u16 v108, v16
    s_mov_b32 exec_hi, 1
    ds_read_u16 v108, v17
    s_mov_b64 exec, -1
    v_mov_b32 v104, 0
    v_mov_b32 v105, 0
    v_mov_b32 v106, 0
    v_mov_b32 v107, 0
    v_lshrrev_b32 v18, 2, v1
    v_mul_u32_u24 v18, 4160, v18
    v_and_b32 v19, 3, v1
    v_lshl_add_u32 v18, v19, 4, v18
    s_mul_i32 s60, s42, 8320
    s_add_u32 s60, s60, 4096
    s_waitcnt lgkmcnt(0)
    v_lshl_or_b32 v88, v82, 16, v82
    v_lshl_or_b32 v89, v81, 16, v81
    v_lshl_or_b32 v90, v80, 16, v81
    v_lshl_or_b32 v91, v80, 16, v80
    v_lshl_or_b32 v92, v81, 16, v82
    v_lshl_or_b32 v93, v81, 16, v81
    v_lshl_or_b32 v94, v80, 16, v80
    v_lshl_or_b32 v95, v80, 16, v80
    buffer_store_dwordx4 v[88:91], v12, s[44:47], 0 offen offset:0 sc1
    buffer_store_dwordx4 v[92:95], v12, s[44:47], s63 offen offset:0 sc1
    v_lshl_or_b32 v120, v115, 16, v116
    v_lshl_or_b32 v121, v113, 16, v114
    v_lshl_or_b32 v122, v111, 16, v112
    v_lshl_or_b32 v123, v109, 16, v110
    v_lshl_or_b32 v124, v114, 16, v115
    v_lshl_or_b32 v125, v112, 16, v113
    v_lshl_or_b32 v126, v110, 16, v111
    v_lshl_or_b32 v127, v108, 16, v109
    buffer_store_dwordx4 v[120:123], v12, s[44:47], 0 offen offset:1024 sc1
    buffer_store_dwordx4 v[124:127], v12, s[44:47], s63 offen offset:1024 sc1
    s_mov_b64 exec, 0xff
    buffer_store_dwordx4 v[104:107], v18, s[44:47], s60 offen sc1
L_prep_end:
    s_mov_b64 exec, -1
    s_lshl_b32 s50, s95, 8
    s_lshr_b32 s51, s36, 6
    s_lshl_b32 s51, s51, 3
    s_add_u32 s51, s51, s92
    s_lshl_b32 s51, s51, 2
    s_add_u32 s50, s50, s51
    s_mov_b64 exec, -1
    s_load_dwordx2 s[92:93], s[0:1], 112
    s_load_dwordx2 s[84:85], s[0:1], 120
    s_waitcnt lgkmcnt(0)
    s_mov_b32 s94, 256
    s_mov_b32 s95, 0x20000
    s_mov_b32 s86, 6144
    s_mov_b32 s87, 0x20000
    s_add_u32 s84, s84, 0x1120000
    s_addc_u32 s85, s85, 0
    s_cmp_eq_u32 s37, 0
    s_cbranch_scc0 L_sb_prep
    v_mov_b32 v60, 0
    s_mov_b64 exec, 1
    buffer_load_dword v64, v60, s[92:95], 0 offen sc1
    s_waitcnt vmcnt(0)
    s_mov_b32 s90, 0
    s_mov_b64 exec, 1
    s_branch L_wc_zprep
L_wp_zprep:
    buffer_load_dword v64, v60, s[92:95], 0 offen sc1
    s_waitcnt vmcnt(0)
L_wc_zprep:
    s_add_u32 s90, s90, 1
    v_cmp_ne_u32 vcc, 1, v64
    s_nop 0
    s_cmp_eq_u64 vcc, 0
    s_cbranch_scc1 L_wg_zprep
    s_cmp_lt_u32 s90, 0x8000
    s_sleep 8
    s_cbranch_scc1 L_wp_zprep
L_wg_zprep:
    s_mov_b64 exec, -1
L_sb_prep:
    s_waitcnt vmcnt(0)
    s_barrier
    s_cmp_eq_u32 s37, 0
    s_cbranch_scc0 L_sig_prep
    v_mov_b32 v60, s50
    v_mov_b32 v61, 1
    s_mov_b64 exec, 1
    buffer_store_dword v61, v60, s[84:87], 0 offen sc1
    s_mov_b64 exec, -1
L_sig_prep:
    s_branch L_conv
L_idle:
    s_load_dwordx2 s[92:93], s[0:1], 112
    s_load_dwordx2 s[84:85], s[0:1], 120
    s_waitcnt lgkmcnt(0)
    s_mov_b32 s94, 256
    s_mov_b32 s95, 0x20000
    s_mov_b32 s86, 6144
    s_mov_b32 s87, 0x20000
    s_add_u32 s84, s84, 0x1120000
    s_addc_u32 s85, s85, 0
    v_lshrrev_b32 v2, 6, v0
    v_and_b32 v1, 63, v0
    v_readfirstlane_b32 s20, v2
    s_nop 0
    s_cmp_eq_u32 s20, 0
    s_cbranch_scc0 L_gemm2
    v_mov_b32 v60, 0
    s_cmp_eq_u32 s2, 480
    s_cbranch_scc0 L_idle_w
    v_mov_b32 v64, 0
    v_mov_b32 v65, 0
    v_mov_b32 v66, 0
    v_mov_b32 v67, 0
    v_lshlrev_b32 v61, 4, v1
    s_mov_b32 s91, 0
    buffer_store_dwordx4 v[64:67], v61, s[84:87], s91 offen sc1
    s_mov_b32 s91, 1024
    buffer_store_dwordx4 v[64:67], v61, s[84:87], s91 offen sc1
    s_mov_b32 s91, 2048
    buffer_store_dwordx4 v[64:67], v61, s[84:87], s91 offen sc1
    s_mov_b32 s91, 3072
    buffer_store_dwordx4 v[64:67], v61, s[84:87], s91 offen sc1
    s_mov_b32 s91, 4096
    buffer_store_dwordx4 v[64:67], v61, s[84:87], s91 offen sc1
    s_mov_b32 s91, 5120
    buffer_store_dwordx4 v[64:67], v61, s[84:87], s91 offen sc1
    s_waitcnt vmcnt(0)
    s_nop 0
    v_mov_b32 v61, 1
    s_mov_b64 exec, 1
    buffer_store_dword v61, v60, s[92:95], 0 offen sc1
    s_mov_b64 exec, -1
L_idle_w:
    s_mov_b32 s90, 0
    s_mov_b64 exec, 1
L_wp_zi:
    buffer_load_dword v64, v60, s[92:95], 0 offen sc1
    s_waitcnt vmcnt(0)
L_wc_zi:
    s_add_u32 s90, s90, 1
    v_cmp_ne_u32 vcc, 1, v64
    s_nop 0
    s_cmp_eq_u64 vcc, 0
    s_cbranch_scc1 L_wg_zi
    s_cmp_lt_u32 s90, 0x8000
    s_sleep 32
    s_cbranch_scc1 L_wp_zi
L_wg_zi:
    s_mov_b64 exec, -1
L_gemm2:
    s_load_dwordx4 s[4:7], s[0:1], 104
    s_load_dwordx2 s[8:9], s[0:1], 120
    v_lshrrev_b32 v2, 6, v0
    v_and_b32 v1, 63, v0
    v_readfirstlane_b32 s20, v2
    s_sub_u32 s47, s2, 256
    s_and_b32 s21, s47, 7
    s_lshr_b32 s22, s47, 3
    s_lshl_b32 s23, s21, 2
    s_lshr_b32 s24, s22, 3
    s_add_u32 s23, s23, s24
    s_and_b32 s24, s22, 7
    v_lshlrev_b32 v3, 4, v1
    s_mul_i32 s25, s20, 57344
    v_add_u32 v4, s25, v3
    s_mul_i32 s26, s23, 229376
    s_mul_i32 s27, s24, 229376
    s_waitcnt lgkmcnt(0)
    s_add_u32 s12, s8, s26
    s_addc_u32 s13, s9, 0
    s_mov_b32 s14, 229376
    s_mov_b32 s15, 0x20000
    s_add_u32 s16, s8, 0x800000
    s_addc_u32 s17, s9, 0
    s_add_u32 s16, s16, s27
    s_addc_u32 s17, s17, 0
    s_mov_b32 s18, 229376
    s_mov_b32 s19, 0x20000
    s_lshr_b32 s91, s23, 1
    s_lshl_b32 s91, s91, 8
    s_add_u32 s91, s91, 2048
    s_cmp_eq_u32 s20, 0
    s_cbranch_scc0 L_wd_g2
    v_lshl_add_u32 v70, v1, 2, s91
    v_lshrrev_b32 v60, 3, v1
    v_lshlrev_b32 v60, 8, v60
    v_and_b32 v61, 7, v1
    v_lshl_add_u32 v60, v61, 4, v60
    buffer_load_dwordx4 v[64:67], v60, s[84:87], 0 offen sc1
    s_mov_b64 exec, 0x3fff
    buffer_load_dword v71, v70, s[84:87], 0 offen sc1
    s_waitcnt vmcnt(0)
    s_mov_b64 exec, -1
    v_and_b32 v64, v64, v65
    v_and_b32 v66, v66, v67
    v_and_b32 v64, v64, v66
    v_cmp_ne_u32 s[88:89], 1, v64
    v_mov_b32 v72, v60
    v_mov_b32 v60, v70
    v_mov_b32 v64, v71
    s_mov_b32 s90, 0
    s_mov_b64 exec, 0x3fff
    s_branch L_wc_g2a
L_wp_g2a:
    buffer_load_dword v64, v60, s[84:87], 0 offen sc1
    s_waitcnt vmcnt(0)
L_wc_g2a:
    s_add_u32 s90, s90, 1
    v_cmp_ne_u32 vcc, 1, v64
    s_nop 0
    s_cmp_eq_u64 vcc, 0
    s_cbranch_scc1 L_wg_g2a
    s_cmp_lt_u32 s90, 0x8000
    s_sleep 4
    s_cbranch_scc1 L_wp_g2a
L_wg_g2a:
    s_mov_b64 exec, -1
    s_cmp_eq_u64 s[88:89], 0
    s_cbranch_scc1 L_wd_g2
    v_mov_b32 v60, v72
    s_mov_b32 s90, 0
    s_mov_b64 exec, -1
L_wp_g2b:
    buffer_load_dwordx4 v[64:67], v60, s[84:87], 0 offen sc1
    s_waitcnt vmcnt(0)
L_wc_g2b:
    v_and_b32 v64, v64, v65
    v_and_b32 v66, v66, v67
    v_and_b32 v64, v64, v66
    s_add_u32 s90, s90, 1
    v_cmp_ne_u32 vcc, 1, v64
    s_nop 0
    s_cmp_eq_u64 vcc, 0
    s_cbranch_scc1 L_wg_g2b
    s_cmp_lt_u32 s90, 0x8000
    s_sleep 4
    s_cbranch_scc1 L_wp_g2b
L_wg_g2b:
    s_mov_b64 exec, -1
L_wd_g2:
    s_barrier
    s_mov_b32 s40, 0
    buffer_load_dwordx4 v[64:67], v4, s[12:15], s40 offen offset:0
    buffer_load_dwordx4 v[80:83], v4, s[16:19], s40 offen offset:0
    buffer_load_dwordx4 v[68:71], v4, s[12:15], s40 offen offset:1024
    buffer_load_dwordx4 v[84:87], v4, s[16:19], s40 offen offset:1024
    buffer_load_dwordx4 v[72:75], v4, s[12:15], s40 offen offset:2048
    buffer_load_dwordx4 v[88:91], v4, s[16:19], s40 offen offset:2048
    buffer_load_dwordx4 v[76:79], v4, s[12:15], s40 offen offset:3072
    buffer_load_dwordx4 v[92:95], v4, s[16:19], s40 offen offset:3072
    s_mov_b32 s40, 4096
    buffer_load_dwordx4 v[96:99], v4, s[12:15], s40 offen offset:0
    buffer_load_dwordx4 v[112:115], v4, s[16:19], s40 offen offset:0
    buffer_load_dwordx4 v[100:103], v4, s[12:15], s40 offen offset:1024
    buffer_load_dwordx4 v[116:119], v4, s[16:19], s40 offen offset:1024
    buffer_load_dwordx4 v[104:107], v4, s[12:15], s40 offen offset:2048
    buffer_load_dwordx4 v[120:123], v4, s[16:19], s40 offen offset:2048
    buffer_load_dwordx4 v[108:111], v4, s[12:15], s40 offen offset:3072
    buffer_load_dwordx4 v[124:127], v4, s[16:19], s40 offen offset:3072
    s_mov_b32 s40, 8192
    buffer_load_dwordx4 v[128:131], v4, s[12:15], s40 offen offset:0
    buffer_load_dwordx4 v[144:147], v4, s[16:19], s40 offen offset:0
    buffer_load_dwordx4 v[132:135], v4, s[12:15], s40 offen offset:1024
    buffer_load_dwordx4 v[148:151], v4, s[16:19], s40 offen offset:1024
    buffer_load_dwordx4 v[136:139], v4, s[12:15], s40 offen offset:2048
    buffer_load_dwordx4 v[152:155], v4, s[16:19], s40 offen offset:2048
    buffer_load_dwordx4 v[140:143], v4, s[12:15], s40 offen offset:3072
    buffer_load_dwordx4 v[156:159], v4, s[16:19], s40 offen offset:3072
    s_add_u32 s28, s8, 0x1200000
    s_addc_u32 s29, s9, 0
    s_mov_b32 s30, 0x200000
    s_mov_b32 s31, 0x20000
    s_add_u32 s32, s8, 0x1100000
    s_addc_u32 s33, s9, 0
    s_mov_b32 s34, 0x4000
    s_mov_b32 s35, 0x20000
    s_mov_b32 s36, s4
    s_mov_b32 s37, s5
    s_mov_b32 s38, 0x200000
    s_mov_b32 s39, 0x20000
    s_add_u32 s44, s8, 0x1110000
    s_addc_u32 s45, s9, 0
    s_mov_b32 s46, 0x8000
    s_mov_b32 s47, 0x20000
    v_mov_b32 v192, 0
    v_mov_b32 v193, 0
    v_mov_b32 v194, 0
    v_mov_b32 v195, 0
    v_mov_b32 v196, 0
    v_mov_b32 v197, 0
    v_mov_b32 v198, 0
    v_mov_b32 v199, 0
    v_mov_b32 v200, 0
    v_mov_b32 v201, 0
    v_mov_b32 v202, 0
    v_mov_b32 v203, 0
    v_mov_b32 v204, 0
    v_mov_b32 v205, 0
    v_mov_b32 v206, 0
    v_mov_b32 v207, 0
    v_mov_b32 v208, 0
    v_mov_b32 v209, 0
    v_mov_b32 v210, 0
    v_mov_b32 v211, 0
    v_mov_b32 v212, 0
    v_mov_b32 v213, 0
    v_mov_b32 v214, 0
    v_mov_b32 v215, 0
    v_mov_b32 v216, 0
    v_mov_b32 v217, 0
    v_mov_b32 v218, 0
    v_mov_b32 v219, 0
    v_mov_b32 v220, 0
    v_mov_b32 v221, 0
    v_mov_b32 v222, 0
    v_mov_b32 v223, 0
    v_mov_b32 v224, 0
    v_mov_b32 v225, 0
    v_mov_b32 v226, 0
    v_mov_b32 v227, 0
    v_mov_b32 v228, 0
    v_mov_b32 v229, 0
    v_mov_b32 v230, 0
    v_mov_b32 v231, 0
    v_mov_b32 v232, 0
    v_mov_b32 v233, 0
    v_mov_b32 v234, 0
    v_mov_b32 v235, 0
    v_mov_b32 v236, 0
    v_mov_b32 v237, 0
    v_mov_b32 v238, 0
    v_mov_b32 v239, 0
    v_mov_b32 v240, 0
    v_mov_b32 v241, 0
    v_mov_b32 v242, 0
    v_mov_b32 v243, 0
    v_mov_b32 v244, 0
    v_mov_b32 v245, 0
    v_mov_b32 v246, 0
    v_mov_b32 v247, 0
    v_mov_b32 v248, 0
    v_mov_b32 v249, 0
    v_mov_b32 v250, 0
    v_mov_b32 v251, 0
    v_mov_b32 v252, 0
    v_mov_b32 v253, 0
    v_mov_b32 v254, 0
    v_mov_b32 v255, 0
    v_and_b32 v11, 31, v1
    v_lshlrev_b32 v11, 2, v11
    s_lshl_b32 s43, s24, 5
    s_add_u32 s43, s43, s23
    s_lshl_b32 s43, s43, 7
    v_and_b32 v5, 15, v1
    s_lshl_b32 s41, s23, 6
    s_lshl_b32 s42, s20, 4
    s_add_u32 s41, s41, s42
    v_add_u32 v6, s41, v5
    v_lshlrev_b32 v7, 3, v6
    v_lshrrev_b32 v13, 3, v1
    v_and_b32 v14, 7, v1
    v_lshlrev_b32 v15, 12, v13
    v_lshl_add_u32 v15, v14, 4, v15
    s_lshl_b32 s50, s24, 18
    s_lshl_b32 s51, s20, 16
    s_add_u32 s50, s50, s51
    s_lshl_b32 s51, s23, 7
    s_add_u32 s50, s50, s51
    s_add_u32 s52, s50, 0x8000
    s_mov_b32 s40, 12288
    buffer_load_dwordx4 v[160:163], v4, s[12:15], s40 offen offset:0
    buffer_load_dwordx4 v[176:179], v4, s[16:19], s40 offen offset:0
    buffer_load_dwordx4 v[164:167], v4, s[12:15], s40 offen offset:1024
    buffer_load_dwordx4 v[180:183], v4, s[16:19], s40 offen offset:1024
    buffer_load_dwordx4 v[168:171], v4, s[12:15], s40 offen offset:2048
    buffer_load_dwordx4 v[184:187], v4, s[16:19], s40 offen offset:2048
    buffer_load_dwordx4 v[172:175], v4, s[12:15], s40 offen offset:3072
    buffer_load_dwordx4 v[188:191], v4, s[16:19], s40 offen offset:3072
    s_waitcnt vmcnt(24)
    v_mfma_f32_16x16x32_bf16 v[192:195], v[80:83], v[64:67], v[192:195]
    v_mfma_f32_16x16x32_bf16 v[196:199], v[80:83], v[68:71], v[196:199]
    v_mfma_f32_16x16x32_bf16 v[200:203], v[80:83], v[72:75], v[200:203]
    v_mfma_f32_16x16x32_bf16 v[204:207], v[80:83], v[76:79], v[204:207]
    v_mfma_f32_16x16x32_bf16 v[208:211], v[84:87], v[64:67], v[208:211]
    v_mfma_f32_16x16x32_bf16 v[212:215], v[84:87], v[68:71], v[212:215]
    v_mfma_f32_16x16x32_bf16 v[216:219], v[84:87], v[72:75], v[216:219]
    v_mfma_f32_16x16x32_bf16 v[220:223], v[84:87], v[76:79], v[220:223]
    v_mfma_f32_16x16x32_bf16 v[224:227], v[88:91], v[64:67], v[224:227]
    v_mfma_f32_16x16x32_bf16 v[228:231], v[88:91], v[68:71], v[228:231]
    v_mfma_f32_16x16x32_bf16 v[232:235], v[88:91], v[72:75], v[232:235]
    v_mfma_f32_16x16x32_bf16 v[236:239], v[88:91], v[76:79], v[236:239]
    v_mfma_f32_16x16x32_bf16 v[240:243], v[92:95], v[64:67], v[240:243]
    v_mfma_f32_16x16x32_bf16 v[244:247], v[92:95], v[68:71], v[244:247]
    v_mfma_f32_16x16x32_bf16 v[248:251], v[92:95], v[72:75], v[248:251]
    v_mfma_f32_16x16x32_bf16 v[252:255], v[92:95], v[76:79], v[252:255]
    s_mov_b32 s40, 16384
    buffer_load_dwordx4 v[64:67], v4, s[12:15], s40 offen offset:0
    buffer_load_dwordx4 v[80:83], v4, s[16:19], s40 offen offset:0
    buffer_load_dwordx4 v[68:71], v4, s[12:15], s40 offen offset:1024
    buffer_load_dwordx4 v[84:87], v4, s[16:19], s40 offen offset:1024
    buffer_load_dwordx4 v[72:75], v4, s[12:15], s40 offen offset:2048
    buffer_load_dwordx4 v[88:91], v4, s[16:19], s40 offen offset:2048
    buffer_load_dwordx4 v[76:79], v4, s[12:15], s40 offen offset:3072
    buffer_load_dwordx4 v[92:95], v4, s[16:19], s40 offen offset:3072
    s_waitcnt vmcnt(24)
    v_mfma_f32_16x16x32_bf16 v[192:195], v[112:115], v[96:99], v[192:195]
    v_mfma_f32_16x16x32_bf16 v[196:199], v[112:115], v[100:103], v[196:199]
    v_mfma_f32_16x16x32_bf16 v[200:203], v[112:115], v[104:107], v[200:203]
    v_mfma_f32_16x16x32_bf16 v[204:207], v[112:115], v[108:111], v[204:207]
    v_mfma_f32_16x16x32_bf16 v[208:211], v[116:119], v[96:99], v[208:211]
    v_mfma_f32_16x16x32_bf16 v[212:215], v[116:119], v[100:103], v[212:215]
    v_mfma_f32_16x16x32_bf16 v[216:219], v[116:119], v[104:107], v[216:219]
    v_mfma_f32_16x16x32_bf16 v[220:223], v[116:119], v[108:111], v[220:223]
    v_mfma_f32_16x16x32_bf16 v[224:227], v[120:123], v[96:99], v[224:227]
    v_mfma_f32_16x16x32_bf16 v[228:231], v[120:123], v[100:103], v[228:231]
    v_mfma_f32_16x16x32_bf16 v[232:235], v[120:123], v[104:107], v[232:235]
    v_mfma_f32_16x16x32_bf16 v[236:239], v[120:123], v[108:111], v[236:239]
    v_mfma_f32_16x16x32_bf16 v[240:243], v[124:127], v[96:99], v[240:243]
    v_mfma_f32_16x16x32_bf16 v[244:247], v[124:127], v[100:103], v[244:247]
    v_mfma_f32_16x16x32_bf16 v[248:251], v[124:127], v[104:107], v[248:251]
    v_mfma_f32_16x16x32_bf16 v[252:255], v[124:127], v[108:111], v[252:255]
    s_mov_b32 s40, 20480
    buffer_load_dwordx4 v[96:99], v4, s[12:15], s40 offen offset:0
    buffer_load_dwordx4 v[112:115], v4, s[16:19], s40 offen offset:0
    buffer_load_dwordx4 v[100:103], v4, s[12:15], s40 offen offset:1024
    buffer_load_dwordx4 v[116:119], v4, s[16:19], s40 offen offset:1024
    buffer_load_dwordx4 v[104:107], v4, s[12:15], s40 offen offset:2048
    buffer_load_dwordx4 v[120:123], v4, s[16:19], s40 offen offset:2048
    buffer_load_dwordx4 v[108:111], v4, s[12:15], s40 offen offset:3072
    buffer_load_dwordx4 v[124:127], v4, s[16:19], s40 offen offset:3072
    s_waitcnt vmcnt(24)
    v_mfma_f32_16x16x32_bf16 v[192:195], v[144:147], v[128:131], v[192:195]
    v_mfma_f32_16x16x32_bf16 v[196:199], v[144:147], v[132:135], v[196:199]
    v_mfma_f32_16x16x32_bf16 v[200:203], v[144:147], v[136:139], v[200:203]
    v_mfma_f32_16x16x32_bf16 v[204:207], v[144:147], v[140:143], v[204:207]
    v_mfma_f32_16x16x32_bf16 v[208:211], v[148:151], v[128:131], v[208:211]
    v_mfma_f32_16x16x32_bf16 v[212:215], v[148:151], v[132:135], v[212:215]
    v_mfma_f32_16x16x32_bf16 v[216:219], v[148:151], v[136:139], v[216:219]
    v_mfma_f32_16x16x32_bf16 v[220:223], v[148:151], v[140:143], v[220:223]
    v_mfma_f32_16x16x32_bf16 v[224:227], v[152:155], v[128:131], v[224:227]
    v_mfma_f32_16x16x32_bf16 v[228:231], v[152:155], v[132:135], v[228:231]
    v_mfma_f32_16x16x32_bf16 v[232:235], v[152:155], v[136:139], v[232:235]
    v_mfma_f32_16x16x32_bf16 v[236:239], v[152:155], v[140:143], v[236:239]
    v_mfma_f32_16x16x32_bf16 v[240:243], v[156:159], v[128:131], v[240:243]
    v_mfma_f32_16x16x32_bf16 v[244:247], v[156:159], v[132:135], v[244:247]
    v_mfma_f32_16x16x32_bf16 v[248:251], v[156:159], v[136:139], v[248:251]
    v_mfma_f32_16x16x32_bf16 v[252:255], v[156:159], v[140:143], v[252:255]
    s_mov_b32 s40, 24576
    buffer_load_dwordx4 v[128:131], v4, s[12:15], s40 offen offset:0
    buffer_load_dwordx4 v[144:147], v4, s[16:19], s40 offen offset:0
    buffer_load_dwordx4 v[132:135], v4, s[12:15], s40 offen offset:1024
    buffer_load_dwordx4 v[148:151], v4, s[16:19], s40 offen offset:1024
    buffer_load_dwordx4 v[136:139], v4, s[12:15], s40 offen offset:2048
    buffer_load_dwordx4 v[152:155], v4, s[16:19], s40 offen offset:2048
    buffer_load_dwordx4 v[140:143], v4, s[12:15], s40 offen offset:3072
    buffer_load_dwordx4 v[156:159], v4, s[16:19], s40 offen offset:3072
    s_waitcnt vmcnt(24)
    v_mfma_f32_16x16x32_bf16 v[192:195], v[176:179], v[160:163], v[192:195]
    v_mfma_f32_16x16x32_bf16 v[196:199], v[176:179], v[164:167], v[196:199]
    v_mfma_f32_16x16x32_bf16 v[200:203], v[176:179], v[168:171], v[200:203]
    v_mfma_f32_16x16x32_bf16 v[204:207], v[176:179], v[172:175], v[204:207]
    v_mfma_f32_16x16x32_bf16 v[208:211], v[180:183], v[160:163], v[208:211]
    v_mfma_f32_16x16x32_bf16 v[212:215], v[180:183], v[164:167], v[212:215]
    v_mfma_f32_16x16x32_bf16 v[216:219], v[180:183], v[168:171], v[216:219]
    v_mfma_f32_16x16x32_bf16 v[220:223], v[180:183], v[172:175], v[220:223]
    v_mfma_f32_16x16x32_bf16 v[224:227], v[184:187], v[160:163], v[224:227]
    v_mfma_f32_16x16x32_bf16 v[228:231], v[184:187], v[164:167], v[228:231]
    v_mfma_f32_16x16x32_bf16 v[232:235], v[184:187], v[168:171], v[232:235]
    v_mfma_f32_16x16x32_bf16 v[236:239], v[184:187], v[172:175], v[236:239]
    v_mfma_f32_16x16x32_bf16 v[240:243], v[188:191], v[160:163], v[240:243]
    v_mfma_f32_16x16x32_bf16 v[244:247], v[188:191], v[164:167], v[244:247]
    v_mfma_f32_16x16x32_bf16 v[248:251], v[188:191], v[168:171], v[248:251]
    v_mfma_f32_16x16x32_bf16 v[252:255], v[188:191], v[172:175], v[252:255]
    s_mov_b32 s40, 28672
    buffer_load_dwordx4 v[160:163], v4, s[12:15], s40 offen offset:0
    buffer_load_dwordx4 v[176:179], v4, s[16:19], s40 offen offset:0
    buffer_load_dwordx4 v[164:167], v4, s[12:15], s40 offen offset:1024
    buffer_load_dwordx4 v[180:183], v4, s[16:19], s40 offen offset:1024
    buffer_load_dwordx4 v[168:171], v4, s[12:15], s40 offen offset:2048
    buffer_load_dwordx4 v[184:187], v4, s[16:19], s40 offen offset:2048
    buffer_load_dwordx4 v[172:175], v4, s[12:15], s40 offen offset:3072
    buffer_load_dwordx4 v[188:191], v4, s[16:19], s40 offen offset:3072
    s_waitcnt vmcnt(24)
    v_mfma_f32_16x16x32_bf16 v[192:195], v[80:83], v[64:67], v[192:195]
    v_mfma_f32_16x16x32_bf16 v[196:199], v[80:83], v[68:71], v[196:199]
    v_mfma_f32_16x16x32_bf16 v[200:203], v[80:83], v[72:75], v[200:203]
    v_mfma_f32_16x16x32_bf16 v[204:207], v[80:83], v[76:79], v[204:207]
    v_mfma_f32_16x16x32_bf16 v[208:211], v[84:87], v[64:67], v[208:211]
    v_mfma_f32_16x16x32_bf16 v[212:215], v[84:87], v[68:71], v[212:215]
    v_mfma_f32_16x16x32_bf16 v[216:219], v[84:87], v[72:75], v[216:219]
    v_mfma_f32_16x16x32_bf16 v[220:223], v[84:87], v[76:79], v[220:223]
    v_mfma_f32_16x16x32_bf16 v[224:227], v[88:91], v[64:67], v[224:227]
    v_mfma_f32_16x16x32_bf16 v[228:231], v[88:91], v[68:71], v[228:231]
    v_mfma_f32_16x16x32_bf16 v[232:235], v[88:91], v[72:75], v[232:235]
    v_mfma_f32_16x16x32_bf16 v[236:239], v[88:91], v[76:79], v[236:239]
    v_mfma_f32_16x16x32_bf16 v[240:243], v[92:95], v[64:67], v[240:243]
    v_mfma_f32_16x16x32_bf16 v[244:247], v[92:95], v[68:71], v[244:247]
    v_mfma_f32_16x16x32_bf16 v[248:251], v[92:95], v[72:75], v[248:251]
    v_mfma_f32_16x16x32_bf16 v[252:255], v[92:95], v[76:79], v[252:255]
    s_mov_b32 s40, 32768
    buffer_load_dwordx4 v[64:67], v4, s[12:15], s40 offen offset:0
    buffer_load_dwordx4 v[80:83], v4, s[16:19], s40 offen offset:0
    buffer_load_dwordx4 v[68:71], v4, s[12:15], s40 offen offset:1024
    buffer_load_dwordx4 v[84:87], v4, s[16:19], s40 offen offset:1024
    buffer_load_dwordx4 v[72:75], v4, s[12:15], s40 offen offset:2048
    buffer_load_dwordx4 v[88:91], v4, s[16:19], s40 offen offset:2048
    buffer_load_dwordx4 v[76:79], v4, s[12:15], s40 offen offset:3072
    buffer_load_dwordx4 v[92:95], v4, s[16:19], s40 offen offset:3072
    s_waitcnt vmcnt(24)
    v_mfma_f32_16x16x32_bf16 v[192:195], v[112:115], v[96:99], v[192:195]
    v_mfma_f32_16x16x32_bf16 v[196:199], v[112:115], v[100:103], v[196:199]
    v_mfma_f32_16x16x32_bf16 v[200:203], v[112:115], v[104:107], v[200:203]
    v_mfma_f32_16x16x32_bf16 v[204:207], v[112:115], v[108:111], v[204:207]
    v_mfma_f32_16x16x32_bf16 v[208:211], v[116:119], v[96:99], v[208:211]
    v_mfma_f32_16x16x32_bf16 v[212:215], v[116:119], v[100:103], v[212:215]
    v_mfma_f32_16x16x32_bf16 v[216:219], v[116:119], v[104:107], v[216:219]
    v_mfma_f32_16x16x32_bf16 v[220:223], v[116:119], v[108:111], v[220:223]
    v_mfma_f32_16x16x32_bf16 v[224:227], v[120:123], v[96:99], v[224:227]
    v_mfma_f32_16x16x32_bf16 v[228:231], v[120:123], v[100:103], v[228:231]
    v_mfma_f32_16x16x32_bf16 v[232:235], v[120:123], v[104:107], v[232:235]
    v_mfma_f32_16x16x32_bf16 v[236:239], v[120:123], v[108:111], v[236:239]
    v_mfma_f32_16x16x32_bf16 v[240:243], v[124:127], v[96:99], v[240:243]
    v_mfma_f32_16x16x32_bf16 v[244:247], v[124:127], v[100:103], v[244:247]
    v_mfma_f32_16x16x32_bf16 v[248:251], v[124:127], v[104:107], v[248:251]
    v_mfma_f32_16x16x32_bf16 v[252:255], v[124:127], v[108:111], v[252:255]
    s_mov_b32 s40, 36864
    buffer_load_dwordx4 v[96:99], v4, s[12:15], s40 offen offset:0
    buffer_load_dwordx4 v[112:115], v4, s[16:19], s40 offen offset:0
    buffer_load_dwordx4 v[100:103], v4, s[12:15], s40 offen offset:1024
    buffer_load_dwordx4 v[116:119], v4, s[16:19], s40 offen offset:1024
    buffer_load_dwordx4 v[104:107], v4, s[12:15], s40 offen offset:2048
    buffer_load_dwordx4 v[120:123], v4, s[16:19], s40 offen offset:2048
    buffer_load_dwordx4 v[108:111], v4, s[12:15], s40 offen offset:3072
    buffer_load_dwordx4 v[124:127], v4, s[16:19], s40 offen offset:3072
    s_waitcnt vmcnt(24)
    v_mfma_f32_16x16x32_bf16 v[192:195], v[144:147], v[128:131], v[192:195]
    v_mfma_f32_16x16x32_bf16 v[196:199], v[144:147], v[132:135], v[196:199]
    v_mfma_f32_16x16x32_bf16 v[200:203], v[144:147], v[136:139], v[200:203]
    v_mfma_f32_16x16x32_bf16 v[204:207], v[144:147], v[140:143], v[204:207]
    v_mfma_f32_16x16x32_bf16 v[208:211], v[148:151], v[128:131], v[208:211]
    v_mfma_f32_16x16x32_bf16 v[212:215], v[148:151], v[132:135], v[212:215]
    v_mfma_f32_16x16x32_bf16 v[216:219], v[148:151], v[136:139], v[216:219]
    v_mfma_f32_16x16x32_bf16 v[220:223], v[148:151], v[140:143], v[220:223]
    v_mfma_f32_16x16x32_bf16 v[224:227], v[152:155], v[128:131], v[224:227]
    v_mfma_f32_16x16x32_bf16 v[228:231], v[152:155], v[132:135], v[228:231]
    v_mfma_f32_16x16x32_bf16 v[232:235], v[152:155], v[136:139], v[232:235]
    v_mfma_f32_16x16x32_bf16 v[236:239], v[152:155], v[140:143], v[236:239]
    v_mfma_f32_16x16x32_bf16 v[240:243], v[156:159], v[128:131], v[240:243]
    v_mfma_f32_16x16x32_bf16 v[244:247], v[156:159], v[132:135], v[244:247]
    v_mfma_f32_16x16x32_bf16 v[248:251], v[156:159], v[136:139], v[248:251]
    v_mfma_f32_16x16x32_bf16 v[252:255], v[156:159], v[140:143], v[252:255]
    s_mov_b32 s40, 40960
    buffer_load_dwordx4 v[128:131], v4, s[12:15], s40 offen offset:0
    buffer_load_dwordx4 v[144:147], v4, s[16:19], s40 offen offset:0
    buffer_load_dwordx4 v[132:135], v4, s[12:15], s40 offen offset:1024
    buffer_load_dwordx4 v[148:151], v4, s[16:19], s40 offen offset:1024
    buffer_load_dwordx4 v[136:139], v4, s[12:15], s40 offen offset:2048
    buffer_load_dwordx4 v[152:155], v4, s[16:19], s40 offen offset:2048
    buffer_load_dwordx4 v[140:143], v4, s[12:15], s40 offen offset:3072
    buffer_load_dwordx4 v[156:159], v4, s[16:19], s40 offen offset:3072
    buffer_load_dword v12, v11, s[44:47], s43 offen sc1
    s_waitcnt vmcnt(25)
    v_mfma_f32_16x16x32_bf16 v[192:195], v[176:179], v[160:163], v[192:195]
    v_mfma_f32_16x16x32_bf16 v[196:199], v[176:179], v[164:167], v[196:199]
    v_mfma_f32_16x16x32_bf16 v[200:203], v[176:179], v[168:171], v[200:203]
    v_mfma_f32_16x16x32_bf16 v[204:207], v[176:179], v[172:175], v[204:207]
    v_mfma_f32_16x16x32_bf16 v[208:211], v[180:183], v[160:163], v[208:211]
    v_mfma_f32_16x16x32_bf16 v[212:215], v[180:183], v[164:167], v[212:215]
    v_mfma_f32_16x16x32_bf16 v[216:219], v[180:183], v[168:171], v[216:219]
    v_mfma_f32_16x16x32_bf16 v[220:223], v[180:183], v[172:175], v[220:223]
    v_mfma_f32_16x16x32_bf16 v[224:227], v[184:187], v[160:163], v[224:227]
    v_mfma_f32_16x16x32_bf16 v[228:231], v[184:187], v[164:167], v[228:231]
    v_mfma_f32_16x16x32_bf16 v[232:235], v[184:187], v[168:171], v[232:235]
    v_mfma_f32_16x16x32_bf16 v[236:239], v[184:187], v[172:175], v[236:239]
    v_mfma_f32_16x16x32_bf16 v[240:243], v[188:191], v[160:163], v[240:243]
    v_mfma_f32_16x16x32_bf16 v[244:247], v[188:191], v[164:167], v[244:247]
    v_mfma_f32_16x16x32_bf16 v[248:251], v[188:191], v[168:171], v[248:251]
    v_mfma_f32_16x16x32_bf16 v[252:255], v[188:191], v[172:175], v[252:255]
    s_mov_b32 s40, 45056
    buffer_load_dwordx4 v[160:163], v4, s[12:15], s40 offen offset:0
    buffer_load_dwordx4 v[176:179], v4, s[16:19], s40 offen offset:0
    buffer_load_dwordx4 v[164:167], v4, s[12:15], s40 offen offset:1024
    buffer_load_dwordx4 v[180:183], v4, s[16:19], s40 offen offset:1024
    buffer_load_dwordx4 v[168:171], v4, s[12:15], s40 offen offset:2048
    buffer_load_dwordx4 v[184:187], v4, s[16:19], s40 offen offset:2048
    buffer_load_dwordx4 v[172:175], v4, s[12:15], s40 offen offset:3072
    buffer_load_dwordx4 v[188:191], v4, s[16:19], s40 offen offset:3072
    s_waitcnt vmcnt(25)
    v_mfma_f32_16x16x32_bf16 v[192:195], v[80:83], v[64:67], v[192:195]
    v_mfma_f32_16x16x32_bf16 v[196:199], v[80:83], v[68:71], v[196:199]
    v_mfma_f32_16x16x32_bf16 v[200:203], v[80:83], v[72:75], v[200:203]
    v_mfma_f32_16x16x32_bf16 v[204:207], v[80:83], v[76:79], v[204:207]
    v_mfma_f32_16x16x32_bf16 v[208:211], v[84:87], v[64:67], v[208:211]
    v_mfma_f32_16x16x32_bf16 v[212:215], v[84:87], v[68:71], v[212:215]
    v_mfma_f32_16x16x32_bf16 v[216:219], v[84:87], v[72:75], v[216:219]
    v_mfma_f32_16x16x32_bf16 v[220:223], v[84:87], v[76:79], v[220:223]
    v_mfma_f32_16x16x32_bf16 v[224:227], v[88:91], v[64:67], v[224:227]
    v_mfma_f32_16x16x32_bf16 v[228:231], v[88:91], v[68:71], v[228:231]
    v_mfma_f32_16x16x32_bf16 v[232:235], v[88:91], v[72:75], v[232:235]
    v_mfma_f32_16x16x32_bf16 v[236:239], v[88:91], v[76:79], v[236:239]
    v_mfma_f32_16x16x32_bf16 v[240:243], v[92:95], v[64:67], v[240:243]
    v_mfma_f32_16x16x32_bf16 v[244:247], v[92:95], v[68:71], v[244:247]
    v_mfma_f32_16x16x32_bf16 v[248:251], v[92:95], v[72:75], v[248:251]
    v_mfma_f32_16x16x32_bf16 v[252:255], v[92:95], v[76:79], v[252:255]
    s_mov_b32 s40, 49152
    buffer_load_dwordx4 v[64:67], v4, s[12:15], s40 offen offset:0
    buffer_load_dwordx4 v[80:83], v4, s[16:19], s40 offen offset:0
    buffer_load_dwordx4 v[68:71], v4, s[12:15], s40 offen offset:1024
    buffer_load_dwordx4 v[84:87], v4, s[16:19], s40 offen offset:1024
    buffer_load_dwordx4 v[72:75], v4, s[12:15], s40 offen offset:2048
    buffer_load_dwordx4 v[88:91], v4, s[16:19], s40 offen offset:2048
    buffer_load_dwordx4 v[76:79], v4, s[12:15], s40 offen offset:3072
    buffer_load_dwordx4 v[92:95], v4, s[16:19], s40 offen offset:3072
    s_waitcnt vmcnt(25)
    v_mfma_f32_16x16x32_bf16 v[192:195], v[112:115], v[96:99], v[192:195]
    v_mfma_f32_16x16x32_bf16 v[196:199], v[112:115], v[100:103], v[196:199]
    v_mfma_f32_16x16x32_bf16 v[200:203], v[112:115], v[104:107], v[200:203]
    v_mfma_f32_16x16x32_bf16 v[204:207], v[112:115], v[108:111], v[204:207]
    v_mfma_f32_16x16x32_bf16 v[208:211], v[116:119], v[96:99], v[208:211]
    v_mfma_f32_16x16x32_bf16 v[212:215], v[116:119], v[100:103], v[212:215]
    v_mfma_f32_16x16x32_bf16 v[216:219], v[116:119], v[104:107], v[216:219]
    v_mfma_f32_16x16x32_bf16 v[220:223], v[116:119], v[108:111], v[220:223]
    v_mfma_f32_16x16x32_bf16 v[224:227], v[120:123], v[96:99], v[224:227]
    v_mfma_f32_16x16x32_bf16 v[228:231], v[120:123], v[100:103], v[228:231]
    v_mfma_f32_16x16x32_bf16 v[232:235], v[120:123], v[104:107], v[232:235]
    v_mfma_f32_16x16x32_bf16 v[236:239], v[120:123], v[108:111], v[236:239]
    v_mfma_f32_16x16x32_bf16 v[240:243], v[124:127], v[96:99], v[240:243]
    v_mfma_f32_16x16x32_bf16 v[244:247], v[124:127], v[100:103], v[244:247]
    v_mfma_f32_16x16x32_bf16 v[248:251], v[124:127], v[104:107], v[248:251]
    v_mfma_f32_16x16x32_bf16 v[252:255], v[124:127], v[108:111], v[252:255]
    s_mov_b32 s40, 53248
    buffer_load_dwordx4 v[96:99], v4, s[12:15], s40 offen offset:0
    buffer_load_dwordx4 v[112:115], v4, s[16:19], s40 offen offset:0
    buffer_load_dwordx4 v[100:103], v4, s[12:15], s40 offen offset:1024
    buffer_load_dwordx4 v[116:119], v4, s[16:19], s40 offen offset:1024
    buffer_load_dwordx4 v[104:107], v4, s[12:15], s40 offen offset:2048
    buffer_load_dwordx4 v[120:123], v4, s[16:19], s40 offen offset:2048
    buffer_load_dwordx4 v[108:111], v4, s[12:15], s40 offen offset:3072
    buffer_load_dwordx4 v[124:127], v4, s[16:19], s40 offen offset:3072
    s_waitcnt vmcnt(25)
    v_mfma_f32_16x16x32_bf16 v[192:195], v[144:147], v[128:131], v[192:195]
    v_mfma_f32_16x16x32_bf16 v[196:199], v[144:147], v[132:135], v[196:199]
    v_mfma_f32_16x16x32_bf16 v[200:203], v[144:147], v[136:139], v[200:203]
    v_mfma_f32_16x16x32_bf16 v[204:207], v[144:147], v[140:143], v[204:207]
    v_mfma_f32_16x16x32_bf16 v[208:211], v[148:151], v[128:131], v[208:211]
    v_mfma_f32_16x16x32_bf16 v[212:215], v[148:151], v[132:135], v[212:215]
    v_mfma_f32_16x16x32_bf16 v[216:219], v[148:151], v[136:139], v[216:219]
    v_mfma_f32_16x16x32_bf16 v[220:223], v[148:151], v[140:143], v[220:223]
    v_mfma_f32_16x16x32_bf16 v[224:227], v[152:155], v[128:131], v[224:227]
    v_mfma_f32_16x16x32_bf16 v[228:231], v[152:155], v[132:135], v[228:231]
    v_mfma_f32_16x16x32_bf16 v[232:235], v[152:155], v[136:139], v[232:235]
    v_mfma_f32_16x16x32_bf16 v[236:239], v[152:155], v[140:143], v[236:239]
    v_mfma_f32_16x16x32_bf16 v[240:243], v[156:159], v[128:131], v[240:243]
    v_mfma_f32_16x16x32_bf16 v[244:247], v[156:159], v[132:135], v[244:247]
    v_mfma_f32_16x16x32_bf16 v[248:251], v[156:159], v[136:139], v[248:251]
    v_mfma_f32_16x16x32_bf16 v[252:255], v[156:159], v[140:143], v[252:255]
    s_waitcnt vmcnt(16)
    v_cmp_eq_u32 vcc, 1, v12
    s_nop 0
    s_cmp_eq_u64 vcc, -1
    s_cselect_b32 s53, 1, 0
    buffer_load_dwordx4 v[16:19], v15, s[28:31], s50 offen sc1
    buffer_load_dwordx4 v[20:23], v15, s[28:31], s52 offen sc1
    buffer_load_dwordx2 v[8:9], v7, s[32:35], 0 offen sc1
    v_mfma_f32_16x16x32_bf16 v[192:195], v[176:179], v[160:163], v[192:195]
    v_mfma_f32_16x16x32_bf16 v[196:199], v[176:179], v[164:167], v[196:199]
    v_mfma_f32_16x16x32_bf16 v[200:203], v[176:179], v[168:171], v[200:203]
    v_mfma_f32_16x16x32_bf16 v[204:207], v[176:179], v[172:175], v[204:207]
    v_mfma_f32_16x16x32_bf16 v[208:211], v[180:183], v[160:163], v[208:211]
    v_mfma_f32_16x16x32_bf16 v[212:215], v[180:183], v[164:167], v[212:215]
    v_mfma_f32_16x16x32_bf16 v[216:219], v[180:183], v[168:171], v[216:219]
    v_mfma_f32_16x16x32_bf16 v[220:223], v[180:183], v[172:175], v[220:223]
    v_mfma_f32_16x16x32_bf16 v[224:227], v[184:187], v[160:163], v[224:227]
    v_mfma_f32_16x16x32_bf16 v[228:231], v[184:187], v[164:167], v[228:231]
    v_mfma_f32_16x16x32_bf16 v[232:235], v[184:187], v[168:171], v[232:235]
    v_mfma_f32_16x16x32_bf16 v[236:239], v[184:187], v[172:175], v[236:239]
    v_mfma_f32_16x16x32_bf16 v[240:243], v[188:191], v[160:163], v[240:243]
    v_mfma_f32_16x16x32_bf16 v[244:247], v[188:191], v[164:167], v[244:247]
    v_mfma_f32_16x16x32_bf16 v[248:251], v[188:191], v[168:171], v[248:251]
    v_mfma_f32_16x16x32_bf16 v[252:255], v[188:191], v[172:175], v[252:255]
    s_waitcnt vmcnt(11)
    v_mfma_f32_16x16x32_bf16 v[192:195], v[80:83], v[64:67], v[192:195]
    v_mfma_f32_16x16x32_bf16 v[196:199], v[80:83], v[68:71], v[196:199]
    v_mfma_f32_16x16x32_bf16 v[200:203], v[80:83], v[72:75], v[200:203]
    v_mfma_f32_16x16x32_bf16 v[204:207], v[80:83], v[76:79], v[204:207]
    v_mfma_f32_16x16x32_bf16 v[208:211], v[84:87], v[64:67], v[208:211]
    v_mfma_f32_16x16x32_bf16 v[212:215], v[84:87], v[68:71], v[212:215]
    v_mfma_f32_16x16x32_bf16 v[216:219], v[84:87], v[72:75], v[216:219]
    v_mfma_f32_16x16x32_bf16 v[220:223], v[84:87], v[76:79], v[220:223]
    v_mfma_f32_16x16x32_bf16 v[224:227], v[88:91], v[64:67], v[224:227]
    v_mfma_f32_16x16x32_bf16 v[228:231], v[88:91], v[68:71], v[228:231]
    v_mfma_f32_16x16x32_bf16 v[232:235], v[88:91], v[72:75], v[232:235]
    v_mfma_f32_16x16x32_bf16 v[236:239], v[88:91], v[76:79], v[236:239]
    v_mfma_f32_16x16x32_bf16 v[240:243], v[92:95], v[64:67], v[240:243]
    v_mfma_f32_16x16x32_bf16 v[244:247], v[92:95], v[68:71], v[244:247]
    v_mfma_f32_16x16x32_bf16 v[248:251], v[92:95], v[72:75], v[248:251]
    v_mfma_f32_16x16x32_bf16 v[252:255], v[92:95], v[76:79], v[252:255]
    s_waitcnt vmcnt(3)
    v_mfma_f32_16x16x32_bf16 v[192:195], v[112:115], v[96:99], v[192:195]
    v_mfma_f32_16x16x32_bf16 v[196:199], v[112:115], v[100:103], v[196:199]
    v_mfma_f32_16x16x32_bf16 v[200:203], v[112:115], v[104:107], v[200:203]
    v_mfma_f32_16x16x32_bf16 v[204:207], v[112:115], v[108:111], v[204:207]
    v_mfma_f32_16x16x32_bf16 v[208:211], v[116:119], v[96:99], v[208:211]
    v_mfma_f32_16x16x32_bf16 v[212:215], v[116:119], v[100:103], v[212:215]
    v_mfma_f32_16x16x32_bf16 v[216:219], v[116:119], v[104:107], v[216:219]
    v_mfma_f32_16x16x32_bf16 v[220:223], v[116:119], v[108:111], v[220:223]
    v_mfma_f32_16x16x32_bf16 v[224:227], v[120:123], v[96:99], v[224:227]
    v_mfma_f32_16x16x32_bf16 v[228:231], v[120:123], v[100:103], v[228:231]
    v_mfma_f32_16x16x32_bf16 v[232:235], v[120:123], v[104:107], v[232:235]
    v_mfma_f32_16x16x32_bf16 v[236:239], v[120:123], v[108:111], v[236:239]
    v_mfma_f32_16x16x32_bf16 v[240:243], v[124:127], v[96:99], v[240:243]
    v_mfma_f32_16x16x32_bf16 v[244:247], v[124:127], v[100:103], v[244:247]
    v_mfma_f32_16x16x32_bf16 v[248:251], v[124:127], v[104:107], v[248:251]
    v_mfma_f32_16x16x32_bf16 v[252:255], v[124:127], v[108:111], v[252:255]
    s_lshl_b32 s42, s20, 12
    v_add_u32 v10, s42, v3
    ds_write_b128 v10, v[192:195] offset:0
    ds_write_b128 v10, v[208:211] offset:1024
    ds_write_b128 v10, v[224:227] offset:2048
    ds_write_b128 v10, v[240:243] offset:3072
    ds_write_b128 v10, v[196:199] offset:16384
    ds_write_b128 v10, v[212:215] offset:17408
    ds_write_b128 v10, v[228:231] offset:18432
    ds_write_b128 v10, v[244:247] offset:19456
    ds_write_b128 v10, v[200:203] offset:32768
    ds_write_b128 v10, v[216:219] offset:33792
    ds_write_b128 v10, v[232:235] offset:34816
    ds_write_b128 v10, v[248:251] offset:35840
    ds_write_b128 v10, v[204:207] offset:49152
    ds_write_b128 v10, v[220:223] offset:50176
    ds_write_b128 v10, v[236:239] offset:51200
    ds_write_b128 v10, v[252:255] offset:52224
    s_cmp_eq_u32 s53, 1
    s_cbranch_scc1 L_g2_go
    s_mov_b32 s48, 0
L_g2_poll:
    buffer_load_dword v12, v11, s[44:47], s43 offen sc1
    s_waitcnt vmcnt(0)
    v_cmp_eq_u32 vcc, 1, v12
    s_add_u32 s48, s48, 1
    s_cmp_eq_u64 vcc, -1
    s_cbranch_scc1 L_g2_got
    s_cmp_lt_u32 s48, 0x40000
    s_sleep 4
    s_cbranch_scc1 L_g2_poll
L_g2_got:
    buffer_load_dwordx4 v[16:19], v15, s[28:31], s50 offen sc1
    buffer_load_dwordx4 v[20:23], v15, s[28:31], s52 offen sc1
L_g2_go:
    v_mul_u32_u24 v13, 144, v13
    v_lshl_add_u32 v13, v14, 4, v13
    s_mul_i32 s51, s20, 2304
    s_add_u32 s51, s51, 65536
    v_add_u32 v13, s51, v13
    s_waitcnt vmcnt(0)
    ds_write_b128 v13, v[16:19]
    ds_write_b128 v13, v[20:23] offset:1152
    s_waitcnt lgkmcnt(0)
    s_barrier
    s_lshl_b32 s42, s20, 14
    v_add_u32 v10, s42, v3
    ds_read_b128 v[64:67], v10 offset:0
    ds_read_b128 v[68:71], v10 offset:1024
    ds_read_b128 v[72:75], v10 offset:2048
    ds_read_b128 v[76:79], v10 offset:3072
    ds_read_b128 v[80:83], v10 offset:4096
    ds_read_b128 v[84:87], v10 offset:5120
    ds_read_b128 v[88:91], v10 offset:6144
    ds_read_b128 v[92:95], v10 offset:7168
    ds_read_b128 v[96:99], v10 offset:8192
    ds_read_b128 v[100:103], v10 offset:9216
    ds_read_b128 v[104:107], v10 offset:10240
    ds_read_b128 v[108:111], v10 offset:11264
    ds_read_b128 v[112:115], v10 offset:12288
    ds_read_b128 v[116:119], v10 offset:13312
    ds_read_b128 v[120:123], v10 offset:14336
    ds_read_b128 v[124:127], v10 offset:15360
    v_lshrrev_b32 v13, 4, v1
    v_lshlrev_b32 v13, 3, v13
    v_bfe_u32 v14, v1, 2, 2
    v_add_u32 v13, v13, v14
    v_mul_u32_u24 v13, 144, v13
    v_and_b32 v14, 3, v1
    v_lshl_add_u32 v13, v14, 3, v13
    s_lshl_b32 s51, s20, 5
    s_add_u32 s51, s51, 65536
    v_add_u32 v13, s51, v13
    ds_read_b64_tr_b16 v[24:25], v13 offset:0
    ds_read_b64_tr_b16 v[26:27], v13 offset:576
    ds_read_b64_tr_b16 v[28:29], v13 offset:4608
    ds_read_b64_tr_b16 v[30:31], v13 offset:5184
    s_waitcnt lgkmcnt(0)
    v_add_f32 v64, v64, v80
    v_add_f32 v96, v96, v112
    v_add_f32 v128, v64, v96
    v_add_f32 v65, v65, v81
    v_add_f32 v97, v97, v113
    v_add_f32 v129, v65, v97
    v_add_f32 v66, v66, v82
    v_add_f32 v98, v98, v114
    v_add_f32 v130, v66, v98
    v_add_f32 v67, v67, v83
    v_add_f32 v99, v99, v115
    v_add_f32 v131, v67, v99
    v_add_f32 v68, v68, v84
    v_add_f32 v100, v100, v116
    v_add_f32 v132, v68, v100
    v_add_f32 v69, v69, v85
    v_add_f32 v101, v101, v117
    v_add_f32 v133, v69, v101
    v_add_f32 v70, v70, v86
    v_add_f32 v102, v102, v118
    v_add_f32 v134, v70, v102
    v_add_f32 v71, v71, v87
    v_add_f32 v103, v103, v119
    v_add_f32 v135, v71, v103
    v_add_f32 v72, v72, v88
    v_add_f32 v104, v104, v120
    v_add_f32 v136, v72, v104
    v_add_f32 v73, v73, v89
    v_add_f32 v105, v105, v121
    v_add_f32 v137, v73, v105
    v_add_f32 v74, v74, v90
    v_add_f32 v106, v106, v122
    v_add_f32 v138, v74, v106
    v_add_f32 v75, v75, v91
    v_add_f32 v107, v107, v123
    v_add_f32 v139, v75, v107
    v_add_f32 v76, v76, v92
    v_add_f32 v108, v108, v124
    v_add_f32 v140, v76, v108
    v_add_f32 v77, v77, v93
    v_add_f32 v109, v109, v125
    v_add_f32 v141, v77, v109
    v_add_f32 v78, v78, v94
    v_add_f32 v110, v110, v126
    v_add_f32 v142, v78, v110
    v_add_f32 v79, v79, v95
    v_add_f32 v111, v111, v127
    v_add_f32 v143, v79, v111
    v_cvt_pk_bf16_f32 v32, v128, v129
    v_lshlrev_b32 v33, 16, v32
    v_and_b32 v34, 0xffff0000, v32
    v_mul_f32 v33, v9, v33
    v_mul_f32 v34, v9, v34
    v_cvt_pk_bf16_f32 v32, v33, v34
    v_lshlrev_b32 v35, 16, v24
    v_and_b32 v36, 0xffff0000, v24
    v_mul_f32 v35, v8, v35
    v_mul_f32 v36, v8, v36
    v_cvt_pk_bf16_f32 v37, v35, v36
    v_lshlrev_b32 v33, 16, v32
    v_and_b32 v34, 0xffff0000, v32
    v_lshlrev_b32 v35, 16, v37
    v_and_b32 v36, 0xffff0000, v37
    v_add_f32 v33, v33, v35
    v_add_f32 v34, v34, v36
    v_cvt_pk_bf16_f32 v160, v33, v34
    v_cvt_pk_bf16_f32 v32, v130, v131
    v_lshlrev_b32 v33, 16, v32
    v_and_b32 v34, 0xffff0000, v32
    v_mul_f32 v33, v9, v33
    v_mul_f32 v34, v9, v34
    v_cvt_pk_bf16_f32 v32, v33, v34
    v_lshlrev_b32 v35, 16, v25
    v_and_b32 v36, 0xffff0000, v25
    v_mul_f32 v35, v8, v35
    v_mul_f32 v36, v8, v36
    v_cvt_pk_bf16_f32 v37, v35, v36
    v_lshlrev_b32 v33, 16, v32
    v_and_b32 v34, 0xffff0000, v32
    v_lshlrev_b32 v35, 16, v37
    v_and_b32 v36, 0xffff0000, v37
    v_add_f32 v33, v33, v35
    v_add_f32 v34, v34, v36
    v_cvt_pk_bf16_f32 v161, v33, v34
    v_cvt_pk_bf16_f32 v32, v132, v133
    v_lshlrev_b32 v33, 16, v32
    v_and_b32 v34, 0xffff0000, v32
    v_mul_f32 v33, v9, v33
    v_mul_f32 v34, v9, v34
    v_cvt_pk_bf16_f32 v32, v33, v34
    v_lshlrev_b32 v35, 16, v26
    v_and_b32 v36, 0xffff0000, v26
    v_mul_f32 v35, v8, v35
    v_mul_f32 v36, v8, v36
    v_cvt_pk_bf16_f32 v37, v35, v36
    v_lshlrev_b32 v33, 16, v32
    v_and_b32 v34, 0xffff0000, v32
    v_lshlrev_b32 v35, 16, v37
    v_and_b32 v36, 0xffff0000, v37
    v_add_f32 v33, v33, v35
    v_add_f32 v34, v34, v36
    v_cvt_pk_bf16_f32 v162, v33, v34
    v_cvt_pk_bf16_f32 v32, v134, v135
    v_lshlrev_b32 v33, 16, v32
    v_and_b32 v34, 0xffff0000, v32
    v_mul_f32 v33, v9, v33
    v_mul_f32 v34, v9, v34
    v_cvt_pk_bf16_f32 v32, v33, v34
    v_lshlrev_b32 v35, 16, v27
    v_and_b32 v36, 0xffff0000, v27
    v_mul_f32 v35, v8, v35
    v_mul_f32 v36, v8, v36
    v_cvt_pk_bf16_f32 v37, v35, v36
    v_lshlrev_b32 v33, 16, v32
    v_and_b32 v34, 0xffff0000, v32
    v_lshlrev_b32 v35, 16, v37
    v_and_b32 v36, 0xffff0000, v37
    v_add_f32 v33, v33, v35
    v_add_f32 v34, v34, v36
    v_cvt_pk_bf16_f32 v163, v33, v34
    v_cvt_pk_bf16_f32 v32, v136, v137
    v_lshlrev_b32 v33, 16, v32
    v_and_b32 v34, 0xffff0000, v32
    v_mul_f32 v33, v9, v33
    v_mul_f32 v34, v9, v34
    v_cvt_pk_bf16_f32 v32, v33, v34
    v_lshlrev_b32 v35, 16, v28
    v_and_b32 v36, 0xffff0000, v28
    v_mul_f32 v35, v8, v35
    v_mul_f32 v36, v8, v36
    v_cvt_pk_bf16_f32 v37, v35, v36
    v_lshlrev_b32 v33, 16, v32
    v_and_b32 v34, 0xffff0000, v32
    v_lshlrev_b32 v35, 16, v37
    v_and_b32 v36, 0xffff0000, v37
    v_add_f32 v33, v33, v35
    v_add_f32 v34, v34, v36
    v_cvt_pk_bf16_f32 v164, v33, v34
    v_cvt_pk_bf16_f32 v32, v138, v139
    v_lshlrev_b32 v33, 16, v32
    v_and_b32 v34, 0xffff0000, v32
    v_mul_f32 v33, v9, v33
    v_mul_f32 v34, v9, v34
    v_cvt_pk_bf16_f32 v32, v33, v34
    v_lshlrev_b32 v35, 16, v29
    v_and_b32 v36, 0xffff0000, v29
    v_mul_f32 v35, v8, v35
    v_mul_f32 v36, v8, v36
    v_cvt_pk_bf16_f32 v37, v35, v36
    v_lshlrev_b32 v33, 16, v32
    v_and_b32 v34, 0xffff0000, v32
    v_lshlrev_b32 v35, 16, v37
    v_and_b32 v36, 0xffff0000, v37
    v_add_f32 v33, v33, v35
    v_add_f32 v34, v34, v36
    v_cvt_pk_bf16_f32 v165, v33, v34
    v_cvt_pk_bf16_f32 v32, v140, v141
    v_lshlrev_b32 v33, 16, v32
    v_and_b32 v34, 0xffff0000, v32
    v_mul_f32 v33, v9, v33
    v_mul_f32 v34, v9, v34
    v_cvt_pk_bf16_f32 v32, v33, v34
    v_lshlrev_b32 v35, 16, v30
    v_and_b32 v36, 0xffff0000, v30
    v_mul_f32 v35, v8, v35
    v_mul_f32 v36, v8, v36
    v_cvt_pk_bf16_f32 v37, v35, v36
    v_lshlrev_b32 v33, 16, v32
    v_and_b32 v34, 0xffff0000, v32
    v_lshlrev_b32 v35, 16, v37
    v_and_b32 v36, 0xffff0000, v37
    v_add_f32 v33, v33, v35
    v_add_f32 v34, v34, v36
    v_cvt_pk_bf16_f32 v166, v33, v34
    v_cvt_pk_bf16_f32 v32, v142, v143
    v_lshlrev_b32 v33, 16, v32
    v_and_b32 v34, 0xffff0000, v32
    v_mul_f32 v33, v9, v33
    v_mul_f32 v34, v9, v34
    v_cvt_pk_bf16_f32 v32, v33, v34
    v_lshlrev_b32 v35, 16, v31
    v_and_b32 v36, 0xffff0000, v31
    v_mul_f32 v35, v8, v35
    v_mul_f32 v36, v8, v36
    v_cvt_pk_bf16_f32 v37, v35, v36
    v_lshlrev_b32 v33, 16, v32
    v_and_b32 v34, 0xffff0000, v32
    v_lshlrev_b32 v35, 16, v37
    v_and_b32 v36, 0xffff0000, v37
    v_add_f32 v33, v33, v35
    v_add_f32 v34, v34, v36
    v_cvt_pk_bf16_f32 v167, v33, v34
    v_lshlrev_b32 v6, 10, v6
    v_lshrrev_b32 v13, 4, v1
    v_lshl_add_u32 v6, v13, 4, v6
    s_lshl_b32 s51, s24, 7
    buffer_store_dwordx4 v[160:163], v6, s[36:39], s51 offen
    buffer_store_dwordx4 v[164:167], v6, s[36:39], s51 offen offset:64
    s_endpgm
L_conv:
    s_setprio 2
    s_load_dwordx2 s[4:5], s[0:1], 64
    s_load_dwordx2 s[10:11], s[0:1], 120
    v_lshrrev_b32 v2, 6, v0
    v_and_b32 v1, 63, v0
    v_readfirstlane_b32 s21, v2
    s_nop 0
    s_lshr_b32 s22, s21, 1
    s_and_b32 s23, s21, 1
    s_lshl_b32 s24, s2, 1
    s_add_u32 s24, s24, s22
    s_mul_i32 s25, s22, 37888
    v_lshlrev_b32 v3, 4, v1
    s_mul_i32 s36, s24, 8320
    s_lshl_b32 s37, s23, 3
    s_add_u32 s36, s36, s37
    s_mul_i32 s38, s23, 16640
    s_add_u32 s38, s38, s25
    s_lshl_b32 s40, s24, 12
    s_lshl_b32 s41, s23, 11
    s_add_u32 s40, s40, s41
    s_add_u32 s42, s25, s41
    s_waitcnt lgkmcnt(0)
    s_lshl_b32 s26, s2, 2
    s_load_dword s27, s[4:5], s26
    s_add_u32 s12, s10, 0xa00000
    s_addc_u32 s13, s11, 0
    s_mov_b32 s14, 0x410040
    s_mov_b32 s15, 0x20000
    s_add_u32 s16, s10, 0xf00000
    s_addc_u32 s17, s11, 0
    s_mov_b32 s18, 0x200000
    s_mov_b32 s19, 0x20000
    s_add_u32 m0, s38, 0
    s_add_u32 s39, s36, 0
    buffer_load_dwordx4 v3, s[12:15], s39 offen offset:0 lds
    buffer_load_dwordx4 v3, s[12:15], s39 offen offset:1024 lds
    buffer_load_dwordx4 v3, s[12:15], s39 offen offset:2048 lds
    buffer_load_dwordx4 v3, s[12:15], s39 offen offset:3072 lds
    s_add_u32 m0, s38, 4160
    s_add_u32 s39, s36, 4160
    buffer_load_dwordx4 v3, s[12:15], s39 offen offset:0 lds
    buffer_load_dwordx4 v3, s[12:15], s39 offen offset:1024 lds
    buffer_load_dwordx4 v3, s[12:15], s39 offen offset:2048 lds
    buffer_load_dwordx4 v3, s[12:15], s39 offen offset:3072 lds
    s_add_u32 m0, s38, 8320
    s_add_u32 s39, s36, 4
    buffer_load_dwordx4 v3, s[12:15], s39 offen offset:0 lds
    buffer_load_dwordx4 v3, s[12:15], s39 offen offset:1024 lds
    buffer_load_dwordx4 v3, s[12:15], s39 offen offset:2048 lds
    buffer_load_dwordx4 v3, s[12:15], s39 offen offset:3072 lds
    s_add_u32 m0, s38, 12480
    s_add_u32 s39, s36, 4164
    buffer_load_dwordx4 v3, s[12:15], s39 offen offset:0 lds
    buffer_load_dwordx4 v3, s[12:15], s39 offen offset:1024 lds
    buffer_load_dwordx4 v3, s[12:15], s39 offen offset:2048 lds
    buffer_load_dwordx4 v3, s[12:15], s39 offen offset:3072 lds
    s_lshr_b32 s91, s2, 5
    s_lshl_b32 s91, s91, 8
    s_cmp_eq_u32 s21, 0
    s_cbranch_scc0 L_wd_conv
    v_lshl_add_u32 v60, v1, 2, s91
    s_mov_b32 s90, 0
    s_mov_b64 exec, 0xffffffff
L_wp_conv:
    buffer_load_dword v64, v60, s[84:87], 0 offen sc1
    s_waitcnt vmcnt(0)
L_wc_conv:
    s_add_u32 s90, s90, 1
    v_cmp_ne_u32 vcc, 1, v64
    s_nop 0
    s_cmp_eq_u64 vcc, 0
    s_cbranch_scc1 L_wg_conv
    s_cmp_lt_u32 s90, 0x8000
    s_sleep 16
    s_cbranch_scc1 L_wp_conv
L_wg_conv:
    s_mov_b64 exec, -1
L_wd_conv:
    s_barrier
    s_add_u32 m0, s42, 33760
    s_nop 0
    buffer_load_dwordx4 v3, s[16:19], s40 offen lds
    buffer_load_dwordx4 v3, s[16:19], s40 offen offset:1024 lds
    s_cmp_ge_u32 s2, 224
    s_cbranch_scc1 L_wd_c2
    s_cmp_eq_u32 s21, 0
    s_cbranch_scc0 L_wd_c2
    s_and_b32 s88, s2, 7
    s_lshr_b32 s89, s2, 3
    s_mul_i32 s90, s89, 37
    s_lshr_b32 s90, s90, 8
    s_mul_i32 s91, s90, 7
    s_sub_u32 s89, s89, s91
    s_lshr_b32 s91, s88, 1
    s_lshl_b32 s91, s91, 2
    s_add_u32 s90, s90, s91
    s_and_b32 s88, s88, 1
    s_mul_i32 s88, s88, 7
    s_add_u32 s88, s88, s89
    s_lshl_b32 s90, s90, 8
    s_lshl_b32 s88, s88, 2
    s_add_u32 s90, s90, s88
    s_add_u32 s90, s90, 2048
    v_mov_b32 v60, s90
    s_mov_b32 s90, 0
    s_mov_b64 exec, 1
L_wp_c2:
    buffer_load_dword v64, v60, s[84:87], 0 offen sc1
    s_waitcnt vmcnt(0)
L_wc_c2:
    s_add_u32 s90, s90, 1
    v_cmp_ne_u32 vcc, 1, v64
    s_nop 0
    s_cmp_eq_u64 vcc, 0
    s_cbranch_scc1 L_wg_c2
    s_cmp_lt_u32 s90, 0x40
    s_sleep 8
    s_cbranch_scc1 L_wp_c2
L_wg_c2:
    s_mov_b64 exec, -1
L_wd_c2:
    s_barrier
    s_add_u32 s28, s10, 0x1200000
    s_addc_u32 s29, s11, 0
    s_mov_b32 s30, 0x200000
    s_mov_b32 s31, 0x20000
    s_add_u32 s32, s10, 0x1110000
    s_addc_u32 s33, s11, 0
    s_mov_b32 s34, 0x8000
    s_mov_b32 s35, 0x20000
    v_mov_b32 v4, 0
    v_mov_b32 v5, 0
    v_mov_b32 v6, 0
    v_mov_b32 v7, 0
    s_cmp_eq_u32 s23, 0
    s_cbranch_scc0 L_conv_z1
    s_add_u32 s43, s25, 33280
    v_add_u32 v8, s43, v3
    v_cmp_gt_u32 vcc, 30, v1
    s_nop 0
    s_and_saveexec_b64 s[44:45], vcc
    ds_write_b128 v8, v[4:7]
    s_mov_b64 exec, s[44:45]
    s_branch L_conv_z2
L_conv_z1:
    v_mul_u32_u24 v8, 4160, v1
    s_add_u32 s43, s25, 4096
    v_add_u32 v8, s43, v8
    v_cmp_gt_u32 vcc, 8, v1
    s_nop 0
    s_and_saveexec_b64 s[44:45], vcc
    ds_write_b128 v8, v[4:7]
    s_mov_b64 exec, s[44:45]
L_conv_z2:
    v_and_b32 v9, 15, v1
    v_lshrrev_b32 v10, 4, v1
    v_lshlrev_b32 v11, 5, v9
    v_lshl_add_u32 v11, v10, 4, v11
    s_lshl_b32 s47, s23, 8
    s_add_u32 s47, s47, s25
    s_add_u32 s43, s47, 33280
    v_add_u32 v11, s43, v11
    v_and_b32 v12, 7, v9
    v_sub_u32 v12, 7, v12
    v_mul_u32_u24 v12, 4160, v12
    v_lshrrev_b32 v13, 3, v9
    v_lshlrev_b32 v13, 4, v13
    v_sub_u32 v13, 16, v13
    v_add_u32 v12, v12, v13
    v_lshl_add_u32 v12, v10, 4, v12
    v_add_u32 v12, s47, v12
    v_lshlrev_b32 v13, 5, v9
    v_lshl_add_u32 v13, v10, 3, v13
    s_add_u32 s43, s42, 33760
    v_add_u32 v14, s43, v13
    s_lshl_b32 s46, s24, 12
    s_add_u32 s46, s46, s41
    s_lshl_b32 s48, s23, 12
    s_add_u32 s49, s25, s48
    v_add_u32 v8, s49, v3
    s_xor_b32 s48, s48, 4096
    s_add_u32 s49, s25, s48
    v_add_u32 v15, s49, v3
    v_mov_b32 v16, 0
    v_mov_b32 v17, 0
    v_mov_b32 v18, 0
    v_mov_b32 v19, 0
    v_mov_b32 v20, 0
    v_mov_b32 v21, 0
    v_mov_b32 v22, 0
    v_mov_b32 v23, 0
    v_mov_b32 v24, 0
    v_mov_b32 v25, 0
    v_mov_b32 v26, 0
    v_mov_b32 v27, 0
    v_mov_b32 v28, 0
    v_mov_b32 v29, 0
    v_mov_b32 v30, 0
    v_mov_b32 v31, 0
    v_mov_b32 v32, 0
    v_mov_b32 v33, 0
    v_mov_b32 v34, 0
    v_mov_b32 v35, 0
    v_mov_b32 v36, 0
    v_mov_b32 v37, 0
    v_mov_b32 v38, 0
    v_mov_b32 v39, 0
    v_mov_b32 v40, 0
    v_mov_b32 v41, 0
    v_mov_b32 v42, 0
    v_mov_b32 v43, 0
    v_mov_b32 v44, 0
    v_mov_b32 v45, 0
    v_mov_b32 v46, 0
    v_mov_b32 v47, 0
    s_lshl_b32 s47, s22, 4
    s_waitcnt lgkmcnt(0)
    s_lshr_b32 s27, s27, s47
    s_lshl_b32 s27, s27, 16
    s_waitcnt vmcnt(0)
    s_barrier
    s_setprio 2
    ds_read_b128 v[80:83], v11 offset:0
    ds_read_b128 v[48:51], v12 offset:3584
    ds_read_b128 v[52:55], v12 offset:3072
    ds_read_b128 v[56:59], v12 offset:2560
    ds_read_b128 v[60:63], v12 offset:2048
    ds_read_b128 v[64:67], v12 offset:1536
    ds_read_b128 v[68:71], v12 offset:1024
    ds_read_b128 v[72:75], v12 offset:512
    ds_read_b128 v[76:79], v12 offset:0
    ds_read_b128 v[84:87], v11 offset:512
    ds_read_b128 v[88:91], v11 offset:1024
    ds_read_b128 v[92:95], v11 offset:1536
    s_waitcnt lgkmcnt(3)
    ds_read_b128 v[96:99], v11 offset:2048
    v_mfma_f32_16x16x32_bf16 v[16:19], v[48:51], v[80:83], v[16:19]
    ds_read_b128 v[100:103], v11 offset:2560
    v_mfma_f32_16x16x32_bf16 v[20:23], v[52:55], v[80:83], v[20:23]
    ds_read_b128 v[104:107], v11 offset:3072
    v_mfma_f32_16x16x32_bf16 v[24:27], v[56:59], v[80:83], v[24:27]
    ds_read_b128 v[108:111], v11 offset:3584
    v_mfma_f32_16x16x32_bf16 v[28:31], v[60:63], v[80:83], v[28:31]
    v_mfma_f32_16x16x32_bf16 v[32:35], v[64:67], v[80:83], v[32:35]
    v_mfma_f32_16x16x32_bf16 v[36:39], v[68:71], v[80:83], v[36:39]
    v_mfma_f32_16x16x32_bf16 v[40:43], v[72:75], v[80:83], v[40:43]
    v_mfma_f32_16x16x32_bf16 v[44:47], v[76:79], v[80:83], v[44:47]
    s_waitcnt lgkmcnt(0)
    v_mfma_f32_16x16x32_bf16 v[20:23], v[48:51], v[84:87], v[20:23]
    v_mfma_f32_16x16x32_bf16 v[24:27], v[52:55], v[84:87], v[24:27]
    v_mfma_f32_16x16x32_bf16 v[28:31], v[56:59], v[84:87], v[28:31]
    v_mfma_f32_16x16x32_bf16 v[32:35], v[60:63], v[84:87], v[32:35]
    v_mfma_f32_16x16x32_bf16 v[36:39], v[64:67], v[84:87], v[36:39]
    v_mfma_f32_16x16x32_bf16 v[40:43], v[68:71], v[84:87], v[40:43]
    v_mfma_f32_16x16x32_bf16 v[44:47], v[72:75], v[84:87], v[44:47]
    v_mfma_f32_16x16x32_bf16 v[24:27], v[48:51], v[88:91], v[24:27]
    v_mfma_f32_16x16x32_bf16 v[28:31], v[52:55], v[88:91], v[28:31]
    ds_read_b128 v[144:147], v11 offset:64
    v_mfma_f32_16x16x32_bf16 v[32:35], v[56:59], v[88:91], v[32:35]
    ds_read_b128 v[112:115], v12 offset:3648
    v_mfma_f32_16x16x32_bf16 v[36:39], v[60:63], v[88:91], v[36:39]
    ds_read_b128 v[116:119], v12 offset:3136
    v_mfma_f32_16x16x32_bf16 v[40:43], v[64:67], v[88:91], v[40:43]
    ds_read_b128 v[120:123], v12 offset:2624
    v_mfma_f32_16x16x32_bf16 v[44:47], v[68:71], v[88:91], v[44:47]
    ds_read_b128 v[124:127], v12 offset:2112
    v_mfma_f32_16x16x32_bf16 v[28:31], v[48:51], v[92:95], v[28:31]
    ds_read_b128 v[128:131], v12 offset:1600
    v_mfma_f32_16x16x32_bf16 v[32:35], v[52:55], v[92:95], v[32:35]
    ds_read_b128 v[132:135], v12 offset:1088
    v_mfma_f32_16x16x32_bf16 v[36:39], v[56:59], v[92:95], v[36:39]
    ds_read_b128 v[136:139], v12 offset:576
    v_mfma_f32_16x16x32_bf16 v[40:43], v[60:63], v[92:95], v[40:43]
    ds_read_b128 v[140:143], v12 offset:64
    v_mfma_f32_16x16x32_bf16 v[44:47], v[64:67], v[92:95], v[44:47]
    ds_read_b128 v[148:151], v11 offset:576
    v_mfma_f32_16x16x32_bf16 v[32:35], v[48:51], v[96:99], v[32:35]
    ds_read_b128 v[152:155], v11 offset:1088
    v_mfma_f32_16x16x32_bf16 v[36:39], v[52:55], v[96:99], v[36:39]
    ds_read_b128 v[156:159], v11 offset:1600
    v_mfma_f32_16x16x32_bf16 v[40:43], v[56:59], v[96:99], v[40:43]
    ds_read_b128 v[160:163], v11 offset:2112
    v_mfma_f32_16x16x32_bf16 v[44:47], v[60:63], v[96:99], v[44:47]
    ds_read_b128 v[164:167], v11 offset:2624
    v_mfma_f32_16x16x32_bf16 v[36:39], v[48:51], v[100:103], v[36:39]
    ds_read_b128 v[168:171], v11 offset:3136
    v_mfma_f32_16x16x32_bf16 v[40:43], v[52:55], v[100:103], v[40:43]
    ds_read_b128 v[172:175], v11 offset:3648
    v_mfma_f32_16x16x32_bf16 v[44:47], v[56:59], v[100:103], v[44:47]
    v_mfma_f32_16x16x32_bf16 v[40:43], v[48:51], v[104:107], v[40:43]
    v_mfma_f32_16x16x32_bf16 v[44:47], v[52:55], v[104:107], v[44:47]
    v_mfma_f32_16x16x32_bf16 v[44:47], v[48:51], v[108:111], v[44:47]
    s_waitcnt lgkmcnt(0)
    v_mfma_f32_16x16x32_bf16 v[16:19], v[112:115], v[144:147], v[16:19]
    ds_read_b128 v[80:83], v11 offset:128
    v_mfma_f32_16x16x32_bf16 v[20:23], v[116:119], v[144:147], v[20:23]
    ds_read_b128 v[48:51], v12 offset:3712
    v_mfma_f32_16x16x32_bf16 v[24:27], v[120:123], v[144:147], v[24:27]
    ds_read_b128 v[52:55], v12 offset:3200
    v_mfma_f32_16x16x32_bf16 v[28:31], v[124:127], v[144:147], v[28:31]
    ds_read_b128 v[56:59], v12 offset:2688
    v_mfma_f32_16x16x32_bf16 v[32:35], v[128:131], v[144:147], v[32:35]
    ds_read_b128 v[60:63], v12 offset:2176
    v_mfma_f32_16x16x32_bf16 v[36:39], v[132:135], v[144:147], v[36:39]
    ds_read_b128 v[64:67], v12 offset:1664
    v_mfma_f32_16x16x32_bf16 v[40:43], v[136:139], v[144:147], v[40:43]
    ds_read_b128 v[68:71], v12 offset:1152
    v_mfma_f32_16x16x32_bf16 v[44:47], v[140:143], v[144:147], v[44:47]
    ds_read_b128 v[72:75], v12 offset:640
    v_mfma_f32_16x16x32_bf16 v[20:23], v[112:115], v[148:151], v[20:23]
    ds_read_b128 v[76:79], v12 offset:128
    v_mfma_f32_16x16x32_bf16 v[24:27], v[116:119], v[148:151], v[24:27]
    ds_read_b128 v[84:87], v11 offset:640
    v_mfma_f32_16x16x32_bf16 v[28:31], v[120:123], v[148:151], v[28:31]
    ds_read_b128 v[88:91], v11 offset:1152
    v_mfma_f32_16x16x32_bf16 v[32:35], v[124:127], v[148:151], v[32:35]
    ds_read_b128 v[92:95], v11 offset:1664
    v_mfma_f32_16x16x32_bf16 v[36:39], v[128:131], v[148:151], v[36:39]
    ds_read_b128 v[96:99], v11 offset:2176
    v_mfma_f32_16x16x32_bf16 v[40:43], v[132:135], v[148:151], v[40:43]
    ds_read_b128 v[100:103], v11 offset:2688
    v_mfma_f32_16x16x32_bf16 v[44:47], v[136:139], v[148:151], v[44:47]
    ds_read_b128 v[104:107], v11 offset:3200
    v_mfma_f32_16x16x32_bf16 v[24:27], v[112:115], v[152:155], v[24:27]
    ds_read_b128 v[108:111], v11 offset:3712
    v_mfma_f32_16x16x32_bf16 v[28:31], v[116:119], v[152:155], v[28:31]
    v_mfma_f32_16x16x32_bf16 v[32:35], v[120:123], v[152:155], v[32:35]
    v_mfma_f32_16x16x32_bf16 v[36:39], v[124:127], v[152:155], v[36:39]
    v_mfma_f32_16x16x32_bf16 v[40:43], v[128:131], v[152:155], v[40:43]
    v_mfma_f32_16x16x32_bf16 v[44:47], v[132:135], v[152:155], v[44:47]
    v_mfma_f32_16x16x32_bf16 v[28:31], v[112:115], v[156:159], v[28:31]
    v_mfma_f32_16x16x32_bf16 v[32:35], v[116:119], v[156:159], v[32:35]
    v_mfma_f32_16x16x32_bf16 v[36:39], v[120:123], v[156:159], v[36:39]
    v_mfma_f32_16x16x32_bf16 v[40:43], v[124:127], v[156:159], v[40:43]
    v_mfma_f32_16x16x32_bf16 v[44:47], v[128:131], v[156:159], v[44:47]
    v_mfma_f32_16x16x32_bf16 v[32:35], v[112:115], v[160:163], v[32:35]
    v_mfma_f32_16x16x32_bf16 v[36:39], v[116:119], v[160:163], v[36:39]
    v_mfma_f32_16x16x32_bf16 v[40:43], v[120:123], v[160:163], v[40:43]
    v_mfma_f32_16x16x32_bf16 v[44:47], v[124:127], v[160:163], v[44:47]
    v_mfma_f32_16x16x32_bf16 v[36:39], v[112:115], v[164:167], v[36:39]
    v_mfma_f32_16x16x32_bf16 v[40:43], v[116:119], v[164:167], v[40:43]
    v_mfma_f32_16x16x32_bf16 v[44:47], v[120:123], v[164:167], v[44:47]
    v_mfma_f32_16x16x32_bf16 v[40:43], v[112:115], v[168:171], v[40:43]
    v_mfma_f32_16x16x32_bf16 v[44:47], v[116:119], v[168:171], v[44:47]
    v_mfma_f32_16x16x32_bf16 v[44:47], v[112:115], v[172:175], v[44:47]
    s_waitcnt lgkmcnt(0)
    v_mfma_f32_16x16x32_bf16 v[16:19], v[48:51], v[80:83], v[16:19]
    ds_read_b128 v[144:147], v11 offset:192
    v_mfma_f32_16x16x32_bf16 v[20:23], v[52:55], v[80:83], v[20:23]
    ds_read_b128 v[112:115], v12 offset:3776
    v_mfma_f32_16x16x32_bf16 v[24:27], v[56:59], v[80:83], v[24:27]
    ds_read_b128 v[116:119], v12 offset:3264
    v_mfma_f32_16x16x32_bf16 v[28:31], v[60:63], v[80:83], v[28:31]
    ds_read_b128 v[120:123], v12 offset:2752
    v_mfma_f32_16x16x32_bf16 v[32:35], v[64:67], v[80:83], v[32:35]
    ds_read_b128 v[124:127], v12 offset:2240
    v_mfma_f32_16x16x32_bf16 v[36:39], v[68:71], v[80:83], v[36:39]
    ds_read_b128 v[128:131], v12 offset:1728
    v_mfma_f32_16x16x32_bf16 v[40:43], v[72:75], v[80:83], v[40:43]
    ds_read_b128 v[132:135], v12 offset:1216
    v_mfma_f32_16x16x32_bf16 v[44:47], v[76:79], v[80:83], v[44:47]
    ds_read_b128 v[136:139], v12 offset:704
    v_mfma_f32_16x16x32_bf16 v[20:23], v[48:51], v[84:87], v[20:23]
    ds_read_b128 v[140:143], v12 offset:192
    v_mfma_f32_16x16x32_bf16 v[24:27], v[52:55], v[84:87], v[24:27]
    ds_read_b128 v[148:151], v11 offset:704
    v_mfma_f32_16x16x32_bf16 v[28:31], v[56:59], v[84:87], v[28:31]
    ds_read_b128 v[152:155], v11 offset:1216
    v_mfma_f32_16x16x32_bf16 v[32:35], v[60:63], v[84:87], v[32:35]
    ds_read_b128 v[156:159], v11 offset:1728
    v_mfma_f32_16x16x32_bf16 v[36:39], v[64:67], v[84:87], v[36:39]
    ds_read_b128 v[160:163], v11 offset:2240
    v_mfma_f32_16x16x32_bf16 v[40:43], v[68:71], v[84:87], v[40:43]
    ds_read_b128 v[164:167], v11 offset:2752
    v_mfma_f32_16x16x32_bf16 v[44:47], v[72:75], v[84:87], v[44:47]
    ds_read_b128 v[168:171], v11 offset:3264
    v_mfma_f32_16x16x32_bf16 v[24:27], v[48:51], v[88:91], v[24:27]
    ds_read_b128 v[172:175], v11 offset:3776
    v_mfma_f32_16x16x32_bf16 v[28:31], v[52:55], v[88:91], v[28:31]
    v_mfma_f32_16x16x32_bf16 v[32:35], v[56:59], v[88:91], v[32:35]
    v_mfma_f32_16x16x32_bf16 v[36:39], v[60:63], v[88:91], v[36:39]
    v_mfma_f32_16x16x32_bf16 v[40:43], v[64:67], v[88:91], v[40:43]
    v_mfma_f32_16x16x32_bf16 v[44:47], v[68:71], v[88:91], v[44:47]
    v_mfma_f32_16x16x32_bf16 v[28:31], v[48:51], v[92:95], v[28:31]
    v_mfma_f32_16x16x32_bf16 v[32:35], v[52:55], v[92:95], v[32:35]
    v_mfma_f32_16x16x32_bf16 v[36:39], v[56:59], v[92:95], v[36:39]
    v_mfma_f32_16x16x32_bf16 v[40:43], v[60:63], v[92:95], v[40:43]
    v_mfma_f32_16x16x32_bf16 v[44:47], v[64:67], v[92:95], v[44:47]
    v_mfma_f32_16x16x32_bf16 v[32:35], v[48:51], v[96:99], v[32:35]
    v_mfma_f32_16x16x32_bf16 v[36:39], v[52:55], v[96:99], v[36:39]
    v_mfma_f32_16x16x32_bf16 v[40:43], v[56:59], v[96:99], v[40:43]
    v_mfma_f32_16x16x32_bf16 v[44:47], v[60:63], v[96:99], v[44:47]
    v_mfma_f32_16x16x32_bf16 v[36:39], v[48:51], v[100:103], v[36:39]
    v_mfma_f32_16x16x32_bf16 v[40:43], v[52:55], v[100:103], v[40:43]
    v_mfma_f32_16x16x32_bf16 v[44:47], v[56:59], v[100:103], v[44:47]
    v_mfma_f32_16x16x32_bf16 v[40:43], v[48:51], v[104:107], v[40:43]
    v_mfma_f32_16x16x32_bf16 v[44:47], v[52:55], v[104:107], v[44:47]
    v_mfma_f32_16x16x32_bf16 v[44:47], v[48:51], v[108:111], v[44:47]
    s_waitcnt lgkmcnt(0)
    v_mfma_f32_16x16x32_bf16 v[16:19], v[112:115], v[144:147], v[16:19]
    v_mfma_f32_16x16x32_bf16 v[20:23], v[116:119], v[144:147], v[20:23]
    v_mfma_f32_16x16x32_bf16 v[24:27], v[120:123], v[144:147], v[24:27]
    v_mfma_f32_16x16x32_bf16 v[28:31], v[124:127], v[144:147], v[28:31]
    v_mfma_f32_16x16x32_bf16 v[32:35], v[128:131], v[144:147], v[32:35]
    v_mfma_f32_16x16x32_bf16 v[36:39], v[132:135], v[144:147], v[36:39]
    v_mfma_f32_16x16x32_bf16 v[40:43], v[136:139], v[144:147], v[40:43]
    v_mfma_f32_16x16x32_bf16 v[44:47], v[140:143], v[144:147], v[44:47]
    v_mfma_f32_16x16x32_bf16 v[20:23], v[112:115], v[148:151], v[20:23]
    v_mfma_f32_16x16x32_bf16 v[24:27], v[116:119], v[148:151], v[24:27]
    v_mfma_f32_16x16x32_bf16 v[28:31], v[120:123], v[148:151], v[28:31]
    v_mfma_f32_16x16x32_bf16 v[32:35], v[124:127], v[148:151], v[32:35]
    v_mfma_f32_16x16x32_bf16 v[36:39], v[128:131], v[148:151], v[36:39]
    v_mfma_f32_16x16x32_bf16 v[40:43], v[132:135], v[148:151], v[40:43]
    v_mfma_f32_16x16x32_bf16 v[44:47], v[136:139], v[148:151], v[44:47]
    v_mfma_f32_16x16x32_bf16 v[24:27], v[112:115], v[152:155], v[24:27]
    v_mfma_f32_16x16x32_bf16 v[28:31], v[116:119], v[152:155], v[28:31]
    v_mfma_f32_16x16x32_bf16 v[32:35], v[120:123], v[152:155], v[32:35]
    v_mfma_f32_16x16x32_bf16 v[36:39], v[124:127], v[152:155], v[36:39]
    v_mfma_f32_16x16x32_bf16 v[40:43], v[128:131], v[152:155], v[40:43]
    v_mfma_f32_16x16x32_bf16 v[44:47], v[132:135], v[152:155], v[44:47]
    v_mfma_f32_16x16x32_bf16 v[28:31], v[112:115], v[156:159], v[28:31]
    v_mfma_f32_16x16x32_bf16 v[32:35], v[116:119], v[156:159], v[32:35]
    v_mfma_f32_16x16x32_bf16 v[36:39], v[120:123], v[156:159], v[36:39]
    v_mfma_f32_16x16x32_bf16 v[40:43], v[124:127], v[156:159], v[40:43]
    v_mfma_f32_16x16x32_bf16 v[44:47], v[128:131], v[156:159], v[44:47]
    v_mfma_f32_16x16x32_bf16 v[32:35], v[112:115], v[160:163], v[32:35]
    v_mfma_f32_16x16x32_bf16 v[36:39], v[116:119], v[160:163], v[36:39]
    v_mfma_f32_16x16x32_bf16 v[40:43], v[120:123], v[160:163], v[40:43]
    v_mfma_f32_16x16x32_bf16 v[44:47], v[124:127], v[160:163], v[44:47]
    v_mfma_f32_16x16x32_bf16 v[36:39], v[112:115], v[164:167], v[36:39]
    v_mfma_f32_16x16x32_bf16 v[40:43], v[116:119], v[164:167], v[40:43]
    v_mfma_f32_16x16x32_bf16 v[44:47], v[120:123], v[164:167], v[44:47]
    v_mfma_f32_16x16x32_bf16 v[40:43], v[112:115], v[168:171], v[40:43]
    v_mfma_f32_16x16x32_bf16 v[44:47], v[116:119], v[168:171], v[44:47]
    v_mfma_f32_16x16x32_bf16 v[44:47], v[112:115], v[172:175], v[44:47]
    s_setprio 2
    s_barrier
    s_cmp_eq_u32 s23, 1
    s_cbranch_scc1 L_conv_x1
    ds_write_b128 v8, v[32:35] offset:0
    ds_write_b128 v8, v[36:39] offset:1024
    ds_write_b128 v8, v[40:43] offset:2048
    s_nop 0
    ds_write_b128 v8, v[44:47] offset:3072
    ds_read_b64 v[96:97], v14 offset:0
    ds_read_b64 v[98:99], v14 offset:512
    ds_read_b64 v[100:101], v14 offset:1024
    ds_read_b64 v[102:103], v14 offset:1536
    s_waitcnt lgkmcnt(0)
    s_barrier
    ds_read_b128 v[64:67], v15 offset:0
    ds_read_b128 v[68:71], v15 offset:1024
    ds_read_b128 v[72:75], v15 offset:2048
    ds_read_b128 v[76:79], v15 offset:3072
    s_waitcnt lgkmcnt(0)
    v_add_f32 v48, v16, v64
    v_add_f32 v49, v17, v65
    v_add_f32 v50, v18, v66
    v_add_f32 v51, v19, v67
    v_add_f32 v52, v20, v68
    v_add_f32 v53, v21, v69
    v_add_f32 v54, v22, v70
    v_add_f32 v55, v23, v71
    v_add_f32 v56, v24, v72
    v_add_f32 v57, v25, v73
    v_add_f32 v58, v26, v74
    v_add_f32 v59, v27, v75
    v_add_f32 v60, v28, v76
    v_add_f32 v61, v29, v77
    v_add_f32 v62, v30, v78
    v_add_f32 v63, v31, v79
    s_branch L_conv_x2
L_conv_x1:
    ds_write_b128 v8, v[16:19] offset:0
    ds_write_b128 v8, v[20:23] offset:1024
    ds_write_b128 v8, v[24:27] offset:2048
    ds_write_b128 v8, v[28:31] offset:3072
    ds_read_b64 v[96:97], v14 offset:0
    ds_read_b64 v[98:99], v14 offset:512
    ds_read_b64 v[100:101], v14 offset:1024
    ds_read_b64 v[102:103], v14 offset:1536
    s_waitcnt lgkmcnt(0)
    s_barrier
    ds_read_b128 v[64:67], v15 offset:0
    ds_read_b128 v[68:71], v15 offset:1024
    ds_read_b128 v[72:75], v15 offset:2048
    ds_read_b128 v[76:79], v15 offset:3072
    s_waitcnt lgkmcnt(0)
    v_add_f32 v48, v32, v64
    v_add_f32 v49, v33, v65
    v_add_f32 v50, v34, v66
    v_add_f32 v51, v35, v67
    v_add_f32 v52, v36, v68
    v_add_f32 v53, v37, v69
    v_add_f32 v54, v38, v70
    v_add_f32 v55, v39, v71
    v_add_f32 v56, v40, v72
    v_add_f32 v57, v41, v73
    v_add_f32 v58, v42, v74
    v_add_f32 v59, v43, v75
    v_add_f32 v60, v44, v76
    v_add_f32 v61, v45, v77
    v_add_f32 v62, v46, v78
    v_add_f32 v63, v47, v79
L_conv_x2:
    v_cvt_pk_bf16_f32 v110, v48, v49
    v_lshlrev_b32 v111, 16, v96
    v_and_b32 v112, 0xffff0000, v96
    v_mul_f32 v111, s27, v111
    v_mul_f32 v112, s27, v112
    v_cvt_pk_bf16_f32 v111, v111, v112
    v_lshlrev_b32 v112, 16, v110
    v_and_b32 v110, 0xffff0000, v110
    v_lshlrev_b32 v113, 16, v111
    v_and_b32 v111, 0xffff0000, v111
    v_add_f32 v112, v112, v113
    v_add_f32 v110, v110, v111
    v_cvt_pk_bf16_f32 v120, v112, v110
    v_cvt_pk_bf16_f32 v110, v50, v51
    v_lshlrev_b32 v111, 16, v97
    v_and_b32 v112, 0xffff0000, v97
    v_mul_f32 v111, s27, v111
    v_mul_f32 v112, s27, v112
    v_cvt_pk_bf16_f32 v111, v111, v112
    v_lshlrev_b32 v112, 16, v110
    v_and_b32 v110, 0xffff0000, v110
    v_lshlrev_b32 v113, 16, v111
    v_and_b32 v111, 0xffff0000, v111
    v_add_f32 v112, v112, v113
    v_add_f32 v110, v110, v111
    v_cvt_pk_bf16_f32 v121, v112, v110
    buffer_store_dwordx2 v[120:121], v13, s[28:31], s46 offen offset:0 sc1
    v_cvt_pk_bf16_f32 v110, v52, v53
    v_lshlrev_b32 v111, 16, v98
    v_and_b32 v112, 0xffff0000, v98
    v_mul_f32 v111, s27, v111
    v_mul_f32 v112, s27, v112
    v_cvt_pk_bf16_f32 v111, v111, v112
    v_lshlrev_b32 v112, 16, v110
    v_and_b32 v110, 0xffff0000, v110
    v_lshlrev_b32 v113, 16, v111
    v_and_b32 v111, 0xffff0000, v111
    v_add_f32 v112, v112, v113
    v_add_f32 v110, v110, v111
    v_cvt_pk_bf16_f32 v122, v112, v110
    v_cvt_pk_bf16_f32 v110, v54, v55
    v_lshlrev_b32 v111, 16, v99
    v_and_b32 v112, 0xffff0000, v99
    v_mul_f32 v111, s27, v111
    v_mul_f32 v112, s27, v112
    v_cvt_pk_bf16_f32 v111, v111, v112
    v_lshlrev_b32 v112, 16, v110
    v_and_b32 v110, 0xffff0000, v110
    v_lshlrev_b32 v113, 16, v111
    v_and_b32 v111, 0xffff0000, v111
    v_add_f32 v112, v112, v113
    v_add_f32 v110, v110, v111
    v_cvt_pk_bf16_f32 v123, v112, v110
    buffer_store_dwordx2 v[122:123], v13, s[28:31], s46 offen offset:512 sc1
    v_cvt_pk_bf16_f32 v110, v56, v57
    v_lshlrev_b32 v111, 16, v100
    v_and_b32 v112, 0xffff0000, v100
    v_mul_f32 v111, s27, v111
    v_mul_f32 v112, s27, v112
    v_cvt_pk_bf16_f32 v111, v111, v112
    v_lshlrev_b32 v112, 16, v110
    v_and_b32 v110, 0xffff0000, v110
    v_lshlrev_b32 v113, 16, v111
    v_and_b32 v111, 0xffff0000, v111
    v_add_f32 v112, v112, v113
    v_add_f32 v110, v110, v111
    v_cvt_pk_bf16_f32 v124, v112, v110
    v_cvt_pk_bf16_f32 v110, v58, v59
    v_lshlrev_b32 v111, 16, v101
    v_and_b32 v112, 0xffff0000, v101
    v_mul_f32 v111, s27, v111
    v_mul_f32 v112, s27, v112
    v_cvt_pk_bf16_f32 v111, v111, v112
    v_lshlrev_b32 v112, 16, v110
    v_and_b32 v110, 0xffff0000, v110
    v_lshlrev_b32 v113, 16, v111
    v_and_b32 v111, 0xffff0000, v111
    v_add_f32 v112, v112, v113
    v_add_f32 v110, v110, v111
    v_cvt_pk_bf16_f32 v125, v112, v110
    buffer_store_dwordx2 v[124:125], v13, s[28:31], s46 offen offset:1024 sc1
    v_cvt_pk_bf16_f32 v110, v60, v61
    v_lshlrev_b32 v111, 16, v102
    v_and_b32 v112, 0xffff0000, v102
    v_mul_f32 v111, s27, v111
    v_mul_f32 v112, s27, v112
    v_cvt_pk_bf16_f32 v111, v111, v112
    v_lshlrev_b32 v112, 16, v110
    v_and_b32 v110, 0xffff0000, v110
    v_lshlrev_b32 v113, 16, v111
    v_and_b32 v111, 0xffff0000, v111
    v_add_f32 v112, v112, v113
    v_add_f32 v110, v110, v111
    v_cvt_pk_bf16_f32 v126, v112, v110
    v_cvt_pk_bf16_f32 v110, v62, v63
    v_lshlrev_b32 v111, 16, v103
    v_and_b32 v112, 0xffff0000, v103
    v_mul_f32 v111, s27, v111
    v_mul_f32 v112, s27, v112
    v_cvt_pk_bf16_f32 v111, v111, v112
    v_lshlrev_b32 v112, 16, v110
    v_and_b32 v110, 0xffff0000, v110
    v_lshlrev_b32 v113, 16, v111
    v_and_b32 v111, 0xffff0000, v111
    v_add_f32 v112, v112, v113
    v_add_f32 v110, v110, v111
    v_cvt_pk_bf16_f32 v127, v112, v110
    buffer_store_dwordx2 v[126:127], v13, s[28:31], s46 offen offset:1536 sc1
    s_waitcnt vmcnt(0)
    s_barrier
    s_cmp_eq_u32 s21, 0
    s_cbranch_scc0 L_conv_end
    s_lshr_b32 s49, s2, 5
    s_lshl_b32 s49, s49, 12
    s_and_b32 s50, s2, 31
    s_lshl_b32 s50, s50, 2
    s_add_u32 s49, s49, s50
    v_lshlrev_b32 v4, 7, v1
    v_mov_b32 v5, 1
    s_mov_b64 exec, 0xffffffff
    buffer_store_dword v5, v4, s[32:35], s49 offen sc1
L_conv_end:
    s_mov_b64 exec, -1
    s_endpgm
L_exit:
    s_endpgm
.section .rodata,"a"
.p2align 6
.amdhsa_kernel gated_mix__ssm_conv_s4__dense_activation_silu__prompt_kernel
  .amdhsa_next_free_vgpr 256
  .amdhsa_next_free_sgpr 102
  .amdhsa_accum_offset 256
  .amdhsa_group_segment_fixed_size 0
  .amdhsa_kernarg_size 128
  .amdhsa_user_sgpr_count 2
  .amdhsa_user_sgpr_kernarg_segment_ptr 1
  .amdhsa_system_sgpr_workgroup_id_x 1
.end_amdhsa_kernel
```
